```python
import torch

def _softmax(x, axis=-1):
    return torch.softmax(x, dim=axis)
def _gelu(x):
    return torch.nn.functional.gelu(x, approximate="tanh")
def _silu(x):
    return torch.nn.functional.silu(x)
def _sigmoid(x):
    return torch.sigmoid(x)
def _layernorm(x, axis=-1, eps=1e-5):
    m = x.mean(dim=axis, keepdim=True)
    v = x.var(dim=axis, keepdim=True, unbiased=False)
    return (x - m) / torch.sqrt(v + eps)
def _scatter_add(tgt, idx, src, axis=0):
    return tgt.clone().index_add_(axis, idx, src)
def _segment_sum(src, seg, n):
    out = torch.zeros((n,) + src.shape[1:], dtype=src.dtype)
    return out.index_add_(0, seg, src)
def _pad(x, pw):
    flat = tuple(v for pair in reversed(pw) for v in pair)
    return torch.nn.functional.pad(x, flat)

kernel_name = 'sequential_preLN__sliding_block_cached__dense_activation_relu__decode'

def setup_inputs():

    _w = (lambda a: (lambda t: t.to(torch.bfloat16) if t.is_floating_point() else t)(torch.as_tensor(a)))
    def _A_setup():
        B, Sq, D = 1, 1, 640
        Hq, Hkv, Sk, Dh = 32, 32, 32768, 192
        assert Hq % Hkv == 0, (Hq, Hkv)
        return {
            "x": _w((lambda *s: torch.randn(*s, dtype=torch.bfloat16) * 0.05)(B, Sq, D)),
            "k_cache": _w((lambda *s: torch.randn(*s, dtype=torch.bfloat16) * 3.2)(B, Hkv, Sk, Dh)),
            "v_cache": _w((lambda *s: torch.randn(*s, dtype=torch.bfloat16) * 0.4)(B, Hkv, Sk, Dh)),
            "wq": _w((lambda *s: torch.randn(*s, dtype=torch.bfloat16) * 3.2)(D, Hq * Dh) * (D ** -0.5)),
            "wo": _w((lambda *s: torch.randn(*s, dtype=torch.bfloat16) * 0.4)(Hq * Dh, D) * ((Hq * Dh) ** -0.5)),
        }
    _A_in = _A_setup()

    def _B_setup():
        B, S, D, Dff = 1, 1, 640, 1536
        return {
            "x": _w((lambda *s: torch.randn(*s, dtype=torch.bfloat16) * 0.05)(B, S, D)),
            "w1": _w((lambda *s: torch.randn(*s, dtype=torch.bfloat16) * 0.05)(D, Dff)),
            "w2": _w((lambda *s: torch.randn(*s, dtype=torch.bfloat16) * 0.05)(Dff, D)),
        }
    _B_in = _B_setup()

    return {
        "A_x": _A_in["x"],
        "A_k_cache": _A_in["k_cache"],
        "A_v_cache": _A_in["v_cache"],
        "A_wq": _A_in["wq"],
        "A_wo": _A_in["wo"],
        "B_x": _B_in["x"],
        "B_w1": _B_in["w1"],
        "B_w2": _B_in["w2"],
    }

def reference(A_x, A_k_cache, A_v_cache, A_wq, A_wo, B_x, B_w1, B_w2):
    def _A_ref(x, k_cache, v_cache, wq, wo):
        B, Sq, D = x.shape
        Hq, Dh = 32, 192
        Hkv, Sk = k_cache.shape[1], k_cache.shape[2]
        W = min(4096, max(256, Sk // 4))
        rep = Hq // Hkv
        q = (lambda x, *d: x.permute(*d))((x @ wq).reshape(B, Sq, Hq, Dh), 0, 2, 1, 3)
        k = (lambda x, n, axis: torch.repeat_interleave(x, n, dim=axis))(k_cache[:, :, Sk - W:, :], rep, axis=1)
        v = (lambda x, n, axis: torch.repeat_interleave(x, n, dim=axis))(v_cache[:, :, Sk - W:, :], rep, axis=1)
        scores = torch.einsum("bhqd,bhkd->bhqk", q, k) * (Dh ** -0.5)
        p = _softmax(scores, axis=-1)
        o = torch.einsum("bhqk,bhkd->bhqd", p, v)
        return (lambda x, *d: x.permute(*d))(o, 0, 2, 1, 3).reshape(B, Sq, Hq * Dh) @ wo

    def _B_ref(x, w1, w2):
        h = torch.einsum("bsd,df->bsf", x, w1)
        zero = torch.zeros_like(h)
        h = torch.maximum(h, zero)
        return torch.einsum("bsf,fd->bsd", h, w2)

    x = A_x
    h = x + _A_ref(_layernorm(x, axis=-1), A_k_cache, A_v_cache, A_wq, A_wo)
    h2 = h + _B_ref(_layernorm(h, axis=-1), B_w1, B_w2)
    return h2
```

```asm
; @launch grid=(256,1,1) block=(640,1,1) lds=69632
.amdgcn_target "amdgcn-amd-amdhsa--gfx950"
.text
.p2align 12
.fill 832, 4, 0xbf810000
.globl sequential_preLN__sliding_block_cached__dense_activation_relu__decode_kernel
.p2align 8
.type sequential_preLN__sliding_block_cached__dense_activation_relu__decode_kernel,@function
sequential_preLN__sliding_block_cached__dense_activation_relu__decode_kernel:
L_start:
    s_load_dwordx16 s[4:19], s[0:1], 0
    s_load_dwordx2 s[20:21], s[0:1], 64
    s_load_dwordx2 s[24:25], s[0:1], 80
    s_cmp_ge_u32 s2, 256
    s_cbranch_scc1 L_end
    v_lshrrev_b32 v1, 6, v0
    v_and_b32 v0, 63, v0
    v_readfirstlane_b32 s26, v1
    s_and_b32 s29, s2, 7
    s_lshr_b32 s30, s2, 3
    s_and_b32 s27, s30, 3
    s_lshl2_add_u32 s27, s29, s27
    s_lshr_b32 s28, s30, 2
    v_lshrrev_b32 v2, 3, v0
    v_and_b32 v3, 7, v0
    v_lshlrev_b32 v3, 4, v3
    s_cmp_lt_u32 s26, 8
    s_cbranch_scc0 L_help
    v_mul_u32_u24 v1, 384, v2
    v_add_u32 v1, v1, v3
    s_mul_i32 s34, s27, 12582912
    s_mul_i32 s35, s28, 3072
    s_add_u32 s34, s34, s35
    s_mul_i32 s35, s26, 24576
    s_add_u32 s34, s34, s35
    s_add_u32 s34, s34, 11010048
    s_mov_b32 s37, 196608
    s_mul_i32 s31, s27, 1
    s_and_b32 s31, s31, 7
    s_mul_i32 s35, s31, 196608
    s_add_u32 s34, s34, s35
    s_mov_b32 s54, -1376256
    s_mov_b32 s55, -1
    s_mov_b32 s56, 196608
    s_mov_b32 s57, 0
    s_waitcnt lgkmcnt(0)
    s_add_u32 s6, s6, s34
    s_addc_u32 s7, s7, 0
    global_load_dwordx4 v[40:43], v1, s[6:7] offset:0 nt
    global_load_dwordx4 v[44:47], v1, s[6:7] offset:128 nt
    s_branch L_stream
L_help:
    s_setprio 3
    s_cmp_eq_u32 s26, 8
    s_cbranch_scc1 L_w8
    v_mov_b32 v8, -1
    v_mov_b32 v9, -1
    v_and_b32 v15, 15, v0
    v_lshlrev_b32 v14, 3, v15
    ds_write_b64 v14, v[8:9] offset:512
    s_waitcnt lgkmcnt(0)
    s_barrier
    s_branch L_w9
L_w8:
    s_mov_b32 s34, 122880
    s_mul_i32 s35, s27, 384
    s_mul_i32 s36, s28, 983040
    s_add_u32 s35, s35, s36
    s_mul_i32 s36, s28, 160
    s_movk_i32 s37, 12288
    v_mad_u32_u24 v1, v2, s34, v3
    v_lshlrev_b32 v36, 4, v0
    v_lshlrev_b32 v37, 2, v0
    v_mad_u32_u24 v38, v2, 20, s36
    s_waitcnt lgkmcnt(0)
    s_load_dword s40, s[24:25], 0
    global_load_dwordx4 v[8:11], v36, s[4:5]
    global_load_dword v12, v37, s[4:5] offset:1024
    global_load_dwordx4 v[160:163], v38, s[4:5]
    global_load_dword v164, v38, s[4:5] offset:16
    s_add_u32 s10, s10, s35
    s_addc_u32 s11, s11, 0
    global_load_dwordx4 v[40:43], v1, s[10:11] offset:0 nt
    global_load_dwordx4 v[44:47], v1, s[10:11] offset:128 nt
    global_load_dwordx4 v[48:51], v1, s[10:11] offset:256 nt
    s_add_u32 s10, s10, s37
    s_addc_u32 s11, s11, 0
    global_load_dwordx4 v[52:55], v1, s[10:11] offset:0 nt
    global_load_dwordx4 v[56:59], v1, s[10:11] offset:128 nt
    global_load_dwordx4 v[60:63], v1, s[10:11] offset:256 nt
    s_add_u32 s10, s10, s37
    s_addc_u32 s11, s11, 0
    global_load_dwordx4 v[64:67], v1, s[10:11] offset:0 nt
    global_load_dwordx4 v[68:71], v1, s[10:11] offset:128 nt
    global_load_dwordx4 v[72:75], v1, s[10:11] offset:256 nt
    s_add_u32 s10, s10, s37
    s_addc_u32 s11, s11, 0
    global_load_dwordx4 v[76:79], v1, s[10:11] offset:0 nt
    global_load_dwordx4 v[80:83], v1, s[10:11] offset:128 nt
    global_load_dwordx4 v[84:87], v1, s[10:11] offset:256 nt
    s_add_u32 s10, s10, s37
    s_addc_u32 s11, s11, 0
    global_load_dwordx4 v[88:91], v1, s[10:11] offset:0 nt
    global_load_dwordx4 v[92:95], v1, s[10:11] offset:128 nt
    global_load_dwordx4 v[96:99], v1, s[10:11] offset:256 nt
    s_add_u32 s10, s10, s37
    s_addc_u32 s11, s11, 0
    global_load_dwordx4 v[100:103], v1, s[10:11] offset:0 nt
    global_load_dwordx4 v[104:107], v1, s[10:11] offset:128 nt
    global_load_dwordx4 v[108:111], v1, s[10:11] offset:256 nt
    s_add_u32 s10, s10, s37
    s_addc_u32 s11, s11, 0
    global_load_dwordx4 v[112:115], v1, s[10:11] offset:0 nt
    global_load_dwordx4 v[116:119], v1, s[10:11] offset:128 nt
    global_load_dwordx4 v[120:123], v1, s[10:11] offset:256 nt
    s_add_u32 s10, s10, s37
    s_addc_u32 s11, s11, 0
    global_load_dwordx4 v[124:127], v1, s[10:11] offset:0 nt
    global_load_dwordx4 v[128:131], v1, s[10:11] offset:128 nt
    global_load_dwordx4 v[132:135], v1, s[10:11] offset:256 nt
    s_add_u32 s10, s10, s37
    s_addc_u32 s11, s11, 0
    global_load_dwordx4 v[136:139], v1, s[10:11] offset:0 nt
    global_load_dwordx4 v[140:143], v1, s[10:11] offset:128 nt
    global_load_dwordx4 v[144:147], v1, s[10:11] offset:256 nt
    s_add_u32 s10, s10, s37
    s_addc_u32 s11, s11, 0
    global_load_dwordx4 v[148:151], v1, s[10:11] offset:0 nt
    global_load_dwordx4 v[152:155], v1, s[10:11] offset:128 nt
    global_load_dwordx4 v[156:159], v1, s[10:11] offset:256 nt
    s_barrier
    v_and_b32 v36, 1, v0
    v_mov_b32 v37, 0xffff
    v_lshlrev_b32 v36, 4, v36
    v_lshlrev_b32 v36, v36, v37
    v_bfe_u32 v37, v0, 1, 2
    v_cmp_eq_u32 vcc, 0, v37
    s_nop 1
    v_cndmask_b32 v4, 0, v36, vcc
    v_cmp_eq_u32 vcc, 1, v37
    s_nop 1
    v_cndmask_b32 v5, 0, v36, vcc
    v_cmp_eq_u32 vcc, 2, v37
    s_nop 1
    v_cndmask_b32 v6, 0, v36, vcc
    v_cmp_eq_u32 vcc, 3, v37
    s_nop 1
    v_cndmask_b32 v7, 0, v36, vcc
    v_lshrrev_b32 v1, 5, v0
    v_mul_u32_u24 v1, 768, v1
    v_lshl_add_u32 v1, v3, 1, v1
    v_and_b32 v39, 16, v0
    v_add_u32 v1, v1, v39
    v_mov_b32 v13, 0
    v_mov_b32 v14, 0
    s_mov_b32 s34, 0x3f803f80
    s_waitcnt vmcnt(30)
    v_dot2c_f32_bf16 v13, s34, v8
    v_dot2c_f32_bf16 v14, v8, v8
    v_dot2c_f32_bf16 v13, s34, v9
    v_dot2c_f32_bf16 v14, v9, v9
    v_dot2c_f32_bf16 v13, s34, v10
    v_dot2c_f32_bf16 v14, v10, v10
    v_dot2c_f32_bf16 v13, s34, v11
    v_dot2c_f32_bf16 v14, v11, v11
    v_dot2c_f32_bf16 v13, s34, v12
    v_dot2c_f32_bf16 v14, v12, v12
    s_nop 1
    v_add_f32_dpp v13, v13, v13 quad_perm:[1,0,3,2] row_mask:0xf bank_mask:0xf
    v_add_f32_dpp v14, v14, v14 quad_perm:[1,0,3,2] row_mask:0xf bank_mask:0xf
    s_nop 0
    v_add_f32_dpp v13, v13, v13 quad_perm:[2,3,0,1] row_mask:0xf bank_mask:0xf
    v_add_f32_dpp v14, v14, v14 quad_perm:[2,3,0,1] row_mask:0xf bank_mask:0xf
    s_nop 0
    v_add_f32_dpp v13, v13, v13 row_half_mirror row_mask:0xf bank_mask:0xf
    v_add_f32_dpp v14, v14, v14 row_half_mirror row_mask:0xf bank_mask:0xf
    s_nop 0
    v_add_f32_dpp v13, v13, v13 row_ror:8 row_mask:0xf bank_mask:0xf
    v_add_f32_dpp v14, v14, v14 row_ror:8 row_mask:0xf bank_mask:0xf
    s_nop 0
    v_add_f32_dpp v13, v13, v13 row_bcast:15 row_mask:0xa bank_mask:0xf
    v_add_f32_dpp v14, v14, v14 row_bcast:15 row_mask:0xa bank_mask:0xf
    s_nop 0
    v_add_f32_dpp v13, v13, v13 row_bcast:31 row_mask:0xc bank_mask:0xf
    v_add_f32_dpp v14, v14, v14 row_bcast:31 row_mask:0xc bank_mask:0xf
    v_readlane_b32 s34, v13, 63
    v_readlane_b32 s35, v14, 63
    s_nop 0
    v_mov_b32 v13, s34
    v_mov_b32 v14, s35
    v_mul_f32 v13, 0x3acccccd, v13
    v_mul_f32 v14, 0x3acccccd, v14
    v_fma_f32 v14, -v13, v13, v14
    v_max_f32 v14, 0, v14
    v_cvt_pk_bf16_f32 v14, 0, v14
    v_add_f32 v14, 0x3727c5ac, v14
    v_cvt_pk_bf16_f32 v14, 0, v14
    v_sqrt_f32 v14, v14
    v_cvt_pk_bf16_f32 v13, 0, v13
    v_cvt_pk_bf16_f32 v14, 0, v14
    v_rcp_f32 v14, v14
    v_lshlrev_b32 v8, 16, v160
    v_and_b32 v9, 0xffff0000, v160
    v_sub_f32 v8, v8, v13
    v_sub_f32 v9, v9, v13
    v_cvt_pk_bf16_f32 v8, 0, v8
    v_cvt_pk_bf16_f32 v9, 0, v9
    v_mul_f32 v8, v8, v14
    v_mul_f32 v9, v9, v14
    v_cvt_pk_bf16_f32 v8, v8, v8
    v_cvt_pk_bf16_f32 v9, v9, v9
    v_and_b32 v28, v4, v8
    v_and_b32 v29, v5, v8
    v_and_b32 v30, v6, v8
    v_and_b32 v31, v7, v8
    v_and_b32 v32, v4, v9
    v_and_b32 v33, v5, v9
    v_and_b32 v34, v6, v9
    v_and_b32 v35, v7, v9
    s_waitcnt vmcnt(24)
    v_mfma_f32_16x16x32_bf16 v[16:19], v[28:31], v[40:43], 0
    v_mfma_f32_16x16x32_bf16 v[20:23], v[28:31], v[44:47], 0
    v_mfma_f32_16x16x32_bf16 v[24:27], v[28:31], v[48:51], 0
    v_mfma_f32_16x16x32_bf16 v[16:19], v[32:35], v[52:55], v[16:19]
    v_mfma_f32_16x16x32_bf16 v[20:23], v[32:35], v[56:59], v[20:23]
    v_mfma_f32_16x16x32_bf16 v[24:27], v[32:35], v[60:63], v[24:27]
    v_lshlrev_b32 v8, 16, v161
    v_and_b32 v9, 0xffff0000, v161
    v_sub_f32 v8, v8, v13
    v_sub_f32 v9, v9, v13
    v_cvt_pk_bf16_f32 v8, 0, v8
    v_cvt_pk_bf16_f32 v9, 0, v9
    v_mul_f32 v8, v8, v14
    v_mul_f32 v9, v9, v14
    v_cvt_pk_bf16_f32 v8, v8, v8
    v_cvt_pk_bf16_f32 v9, v9, v9
    v_and_b32 v28, v4, v8
    v_and_b32 v29, v5, v8
    v_and_b32 v30, v6, v8
    v_and_b32 v31, v7, v8
    v_and_b32 v32, v4, v9
    v_and_b32 v33, v5, v9
    v_and_b32 v34, v6, v9
    v_and_b32 v35, v7, v9
    s_waitcnt vmcnt(18)
    v_mfma_f32_16x16x32_bf16 v[16:19], v[28:31], v[64:67], v[16:19]
    v_mfma_f32_16x16x32_bf16 v[20:23], v[28:31], v[68:71], v[20:23]
    v_mfma_f32_16x16x32_bf16 v[24:27], v[28:31], v[72:75], v[24:27]
    v_mfma_f32_16x16x32_bf16 v[16:19], v[32:35], v[76:79], v[16:19]
    v_mfma_f32_16x16x32_bf16 v[20:23], v[32:35], v[80:83], v[20:23]
    v_mfma_f32_16x16x32_bf16 v[24:27], v[32:35], v[84:87], v[24:27]
    v_lshlrev_b32 v8, 16, v162
    v_and_b32 v9, 0xffff0000, v162
    v_sub_f32 v8, v8, v13
    v_sub_f32 v9, v9, v13
    v_cvt_pk_bf16_f32 v8, 0, v8
    v_cvt_pk_bf16_f32 v9, 0, v9
    v_mul_f32 v8, v8, v14
    v_mul_f32 v9, v9, v14
    v_cvt_pk_bf16_f32 v8, v8, v8
    v_cvt_pk_bf16_f32 v9, v9, v9
    v_and_b32 v28, v4, v8
    v_and_b32 v29, v5, v8
    v_and_b32 v30, v6, v8
    v_and_b32 v31, v7, v8
    v_and_b32 v32, v4, v9
    v_and_b32 v33, v5, v9
    v_and_b32 v34, v6, v9
    v_and_b32 v35, v7, v9
    s_waitcnt vmcnt(12)
    v_mfma_f32_16x16x32_bf16 v[16:19], v[28:31], v[88:91], v[16:19]
    v_mfma_f32_16x16x32_bf16 v[20:23], v[28:31], v[92:95], v[20:23]
    v_mfma_f32_16x16x32_bf16 v[24:27], v[28:31], v[96:99], v[24:27]
    v_mfma_f32_16x16x32_bf16 v[16:19], v[32:35], v[100:103], v[16:19]
    v_mfma_f32_16x16x32_bf16 v[20:23], v[32:35], v[104:107], v[20:23]
    v_mfma_f32_16x16x32_bf16 v[24:27], v[32:35], v[108:111], v[24:27]
    v_lshlrev_b32 v8, 16, v163
    v_and_b32 v9, 0xffff0000, v163
    v_sub_f32 v8, v8, v13
    v_sub_f32 v9, v9, v13
    v_cvt_pk_bf16_f32 v8, 0, v8
    v_cvt_pk_bf16_f32 v9, 0, v9
    v_mul_f32 v8, v8, v14
    v_mul_f32 v9, v9, v14
    v_cvt_pk_bf16_f32 v8, v8, v8
    v_cvt_pk_bf16_f32 v9, v9, v9
    v_and_b32 v28, v4, v8
    v_and_b32 v29, v5, v8
    v_and_b32 v30, v6, v8
    v_and_b32 v31, v7, v8
    v_and_b32 v32, v4, v9
    v_and_b32 v33, v5, v9
    v_and_b32 v34, v6, v9
    v_and_b32 v35, v7, v9
    s_waitcnt vmcnt(6)
    v_mfma_f32_16x16x32_bf16 v[16:19], v[28:31], v[112:115], v[16:19]
    v_mfma_f32_16x16x32_bf16 v[20:23], v[28:31], v[116:119], v[20:23]
    v_mfma_f32_16x16x32_bf16 v[24:27], v[28:31], v[120:123], v[24:27]
    v_mfma_f32_16x16x32_bf16 v[16:19], v[32:35], v[124:127], v[16:19]
    v_mfma_f32_16x16x32_bf16 v[20:23], v[32:35], v[128:131], v[20:23]
    v_mfma_f32_16x16x32_bf16 v[24:27], v[32:35], v[132:135], v[24:27]
    v_lshlrev_b32 v8, 16, v164
    v_and_b32 v9, 0xffff0000, v164
    v_sub_f32 v8, v8, v13
    v_sub_f32 v9, v9, v13
    v_cvt_pk_bf16_f32 v8, 0, v8
    v_cvt_pk_bf16_f32 v9, 0, v9
    v_mul_f32 v8, v8, v14
    v_mul_f32 v9, v9, v14
    v_cvt_pk_bf16_f32 v8, v8, v8
    v_cvt_pk_bf16_f32 v9, v9, v9
    v_and_b32 v28, v4, v8
    v_and_b32 v29, v5, v8
    v_and_b32 v30, v6, v8
    v_and_b32 v31, v7, v8
    v_and_b32 v32, v4, v9
    v_and_b32 v33, v5, v9
    v_and_b32 v34, v6, v9
    v_and_b32 v35, v7, v9
    s_waitcnt vmcnt(0)
    v_mfma_f32_16x16x32_bf16 v[16:19], v[28:31], v[136:139], v[16:19]
    v_mfma_f32_16x16x32_bf16 v[20:23], v[28:31], v[140:143], v[20:23]
    v_mfma_f32_16x16x32_bf16 v[24:27], v[28:31], v[144:147], v[24:27]
    v_mfma_f32_16x16x32_bf16 v[16:19], v[32:35], v[148:151], v[16:19]
    v_mfma_f32_16x16x32_bf16 v[20:23], v[32:35], v[152:155], v[20:23]
    v_mfma_f32_16x16x32_bf16 v[24:27], v[32:35], v[156:159], v[24:27]
    s_waitcnt lgkmcnt(0)
    s_mul_i32 s40, s40, 0x9e3779b1
    s_add_u32 s40, s40, 0x7f4a7c15
    s_getreg_b32 s43, hwreg(HW_REG_XCC_ID, 0, 4)
    s_and_b32 s44, s40, 0xfffffff0
    s_or_b32 s43, s43, s44
    s_lshl_b32 s34, s27, 13
    s_add_u32 s34, s34, 12288
    s_lshl_b32 s35, s28, 10
    s_add_u32 s35, s35, s34
    s_sub_u32 s35, s35, 4096
    v_lshl_add_u32 v8, v0, 4, s35
    v_lshl_add_u32 v9, v0, 4, s34
    v_lshlrev_b32 v10, 2, v0
    s_mov_b32 exec_lo, 0x00ff00ff
    s_mov_b32 exec_hi, 0xff00ff00
    ds_write_b128 v1, v[16:19] offset:1024
    ds_write_b128 v1, v[20:23] offset:1280
    ds_write_b128 v1, v[24:27] offset:1536
    s_mov_b64 exec, -1
    s_waitcnt lgkmcnt(0)
    ds_read2st64_b32 v[16:17], v10 offset0:4 offset1:7
    ds_read2st64_b32 v[18:19], v10 offset0:5 offset1:8
    ds_read2st64_b32 v[20:21], v10 offset0:6 offset1:9
    v_mov_b32 v39, s43
    s_waitcnt lgkmcnt(0)
    v_add_f32 v36, v16, v17
    v_add_f32 v37, v18, v19
    v_add_f32 v38, v20, v21
    global_store_dwordx4 v8, v[36:39], s[24:25]
    s_mov_b32 s41, 262144
L_pq:
    global_load_dwordx4 v[40:43], v9, s[24:25] offset:-4096 sc1
    global_load_dwordx4 v[44:47], v9, s[24:25] offset:-3072 sc1
    global_load_dwordx4 v[48:51], v9, s[24:25] offset:-2048 sc1
    global_load_dwordx4 v[52:55], v9, s[24:25] offset:-1024 sc1
    global_load_dwordx4 v[56:59], v9, s[24:25] offset:0 sc1
    global_load_dwordx4 v[60:63], v9, s[24:25] offset:1024 sc1
    global_load_dwordx4 v[64:67], v9, s[24:25] offset:2048 sc1
    global_load_dwordx4 v[68:71], v9, s[24:25] offset:3072 sc1
    s_cmp_eq_u32 s41, 262138
    s_cbranch_scc0 L_pq_wait
    global_store_dwordx4 v8, v[36:39], s[24:25] sc1
L_pq_wait:
    s_waitcnt vmcnt(0)
    v_min3_u32 v11, v43, v47, v51
    v_min3_u32 v11, v11, v55, v59
    v_min3_u32 v11, v11, v63, v67
    v_min_u32 v11, v11, v71
    v_max3_u32 v12, v43, v47, v51
    v_max3_u32 v12, v12, v55, v59
    v_max3_u32 v12, v12, v63, v67
    v_max_u32 v12, v12, v71
    v_xor_b32 v11, s43, v11
    v_xor_b32 v12, s43, v12
    v_or_b32 v11, v11, v12
    v_cmp_lt_u32 vcc, 15, v11
    s_cbranch_vccz L_pq_ok
    s_sleep 1
    s_sub_u32 s41, s41, 1
    s_cbranch_scc0 L_pq
L_pq_ok:
    v_cmp_ne_u32 vcc, 0, v11
    s_cbranch_vccz L_pq_done
    global_store_dwordx4 v8, v[36:39], s[24:25] sc1
L_pq_done:
    v_add_f32 v40, v40, v44
    v_add_f32 v41, v41, v45
    v_add_f32 v42, v42, v46
    v_add_f32 v40, v40, v48
    v_add_f32 v41, v41, v49
    v_add_f32 v42, v42, v50
    v_add_f32 v40, v40, v52
    v_add_f32 v41, v41, v53
    v_add_f32 v42, v42, v54
    v_add_f32 v40, v40, v56
    v_add_f32 v41, v41, v57
    v_add_f32 v42, v42, v58
    v_add_f32 v40, v40, v60
    v_add_f32 v41, v41, v61
    v_add_f32 v42, v42, v62
    v_add_f32 v40, v40, v64
    v_add_f32 v41, v41, v65
    v_add_f32 v42, v42, v66
    v_add_f32 v40, v40, v68
    v_add_f32 v41, v41, v69
    v_add_f32 v42, v42, v70
    v_cvt_pk_bf16_f32 v40, v40, v41
    v_cvt_pk_bf16_f32 v42, v42, v42
    v_lshlrev_b32 v10, 1, v0
    ds_write_b16 v10, v40 offset:0
    ds_write_b16_d16_hi v10, v40 offset:128
    ds_write_b16 v10, v42 offset:256
    s_waitcnt lgkmcnt(0)
    v_mov_b32 v10, 0
    ds_write_b32 v10, v10 offset:528
    s_cmp_lt_u32 s2, 160
    s_cbranch_scc0 L_w8_rest
    s_mov_b32 m0, 20480
    s_lshr_b32 s42, s27, 1
    s_and_b32 s43, s30, 1
    s_lshl1_add_u32 s43, s28, s43
    s_mul_i32 s34, s42, 491520
    s_lshl_b32 s35, s43, 7
    s_add_u32 s34, s34, s35
    s_add_u32 s44, s12, s34
    s_addc_u32 s45, s13, 0
    v_mul_u32_u24 v36, 1280, v2
    v_add_u32 v36, v36, v3
    s_mov_b32 s34, 0
    s_mov_b32 s41, 262144
L_wt:
    ds_read_b64 v[8:9], v10 offset:512
    s_waitcnt lgkmcnt(0)
    v_cmp_eq_u32 vcc, -1, v9
    s_cbranch_vccz L_wt_ok
    s_sleep 4
    s_sub_u32 s41, s41, 1
    s_cbranch_scc0 L_wt
L_wt_ok:
L_w8_wo:
    s_waitcnt vmcnt(9)
    global_load_lds_dwordx4 v36, s[44:45] nt
    s_add_u32 m0, m0, 1024
    s_add_u32 s44, s44, 81920
    s_addc_u32 s45, s45, 0
    s_waitcnt vmcnt(9)
    global_load_lds_dwordx4 v36, s[44:45] nt
    s_add_u32 m0, m0, 1024
    s_add_u32 s44, s44, 81920
    s_addc_u32 s45, s45, 0
    s_waitcnt vmcnt(9)
    global_load_lds_dwordx4 v36, s[44:45] nt
    s_add_u32 m0, m0, 1024
    s_sub_u32 s44, s44, 153600
    s_subb_u32 s45, s45, 0
    s_waitcnt vmcnt(9)
    global_load_lds_dwordx4 v36, s[44:45] nt
    s_add_u32 m0, m0, 1024
    s_add_u32 s44, s44, 81920
    s_addc_u32 s45, s45, 0
    s_waitcnt vmcnt(9)
    global_load_lds_dwordx4 v36, s[44:45] nt
    s_add_u32 m0, m0, 1024
    s_add_u32 s44, s44, 81920
    s_addc_u32 s45, s45, 0
    s_waitcnt vmcnt(9)
    global_load_lds_dwordx4 v36, s[44:45] nt
    s_add_u32 m0, m0, 1024
    s_sub_u32 s44, s44, 153600
    s_subb_u32 s45, s45, 0
    s_add_u32 s34, s34, 1
    s_cmp_eq_u32 s34, 4
    s_cbranch_scc0 L_w8_wo_same
    s_add_u32 s44, s44, 163840
    s_addc_u32 s45, s45, 0
L_w8_wo_same:
    s_cmp_lt_u32 s34, 5
    s_cbranch_scc1 L_w8_wo
    s_mov_b32 s41, 262144
L_vi:
    ds_read_b32 v8, v10 offset:540
    s_waitcnt lgkmcnt(0)
    v_cmp_gt_i32 vcc, 7, v8
    s_cbranch_vccz L_vi_ok
    s_sleep 1
    s_sub_u32 s41, s41, 1
    s_cbranch_scc0 L_vi
L_vi_ok:
L_w8_wo2:
    global_load_lds_dwordx4 v36, s[44:45] nt
    s_add_u32 m0, m0, 1024
    s_add_u32 s44, s44, 81920
    s_addc_u32 s45, s45, 0
    global_load_lds_dwordx4 v36, s[44:45] nt
    s_add_u32 m0, m0, 1024
    s_add_u32 s44, s44, 81920
    s_addc_u32 s45, s45, 0
    global_load_lds_dwordx4 v36, s[44:45] nt
    s_add_u32 m0, m0, 1024
    s_sub_u32 s44, s44, 153600
    s_subb_u32 s45, s45, 0
    global_load_lds_dwordx4 v36, s[44:45] nt
    s_add_u32 m0, m0, 1024
    s_add_u32 s44, s44, 81920
    s_addc_u32 s45, s45, 0
    global_load_lds_dwordx4 v36, s[44:45] nt
    s_add_u32 m0, m0, 1024
    s_add_u32 s44, s44, 81920
    s_addc_u32 s45, s45, 0
    global_load_lds_dwordx4 v36, s[44:45] nt
    s_add_u32 m0, m0, 1024
    s_sub_u32 s44, s44, 153600
    s_subb_u32 s45, s45, 0
    s_add_u32 s34, s34, 1
    s_cmp_eq_u32 s34, 4
    s_cbranch_scc0 L_w8_wo2_same
    s_add_u32 s44, s44, 163840
    s_addc_u32 s45, s45, 0
L_w8_wo2_same:
    s_cmp_lt_u32 s34, 8
    s_cbranch_scc1 L_w8_wo2
    s_waitcnt vmcnt(0)
    s_barrier
    s_endpgm
.p2align 12
L_stream:
    s_add_u32 s8, s8, s34
    s_addc_u32 s9, s9, 0
    s_barrier
    global_load_dwordx4 v[48:51], v1, s[6:7] offset:256 nt
    s_cmp_eq_u32 s31, 7
    s_cselect_b64 s[38:39], s[54:55], s[56:57]
    s_add_u32 s6, s6, s38
    s_addc_u32 s7, s7, s39
    v_and_b32 v36, 1, v0
    v_mov_b32 v37, 0xffff
    v_lshlrev_b32 v36, 4, v36
    v_lshlrev_b32 v36, v36, v37
    v_bfe_u32 v37, v0, 1, 2
    v_cmp_eq_u32 vcc, 0, v37
    s_nop 1
    v_cndmask_b32 v4, 0, v36, vcc
    v_cmp_eq_u32 vcc, 1, v37
    s_nop 1
    v_cndmask_b32 v5, 0, v36, vcc
    v_cmp_eq_u32 vcc, 2, v37
    s_nop 1
    v_cndmask_b32 v6, 0, v36, vcc
    v_cmp_eq_u32 vcc, 3, v37
    s_nop 1
    v_cndmask_b32 v7, 0, v36, vcc
    s_sub_u32 s35, s2, 160
    s_cmp_lt_u32 s35, 48
    s_cselect_b64 vcc, -1, 0
    s_waitcnt vmcnt(2)
    global_load_dwordx4 v[52:55], v1, s[6:7] offset:0 nt
    s_waitcnt vmcnt(2)
    global_load_dwordx4 v[56:59], v1, s[6:7] offset:128 nt
    s_waitcnt vmcnt(2)
    global_load_dwordx4 v[60:63], v1, s[6:7] offset:256 nt
    s_cmp_eq_u32 s31, 6
    s_cselect_b64 s[38:39], s[54:55], s[56:57]
    s_add_u32 s6, s6, s38
    s_addc_u32 s7, s7, s39
    s_waitcnt vmcnt(2)
    global_load_dwordx4 v[64:67], v1, s[6:7] offset:0 nt
    s_waitcnt vmcnt(2)
    global_load_dwordx4 v[68:71], v1, s[6:7] offset:128 nt
    s_waitcnt vmcnt(2)
    global_load_dwordx4 v[72:75], v1, s[6:7] offset:256 nt
    s_cmp_eq_u32 s31, 5
    s_cselect_b64 s[38:39], s[54:55], s[56:57]
    s_add_u32 s6, s6, s38
    s_addc_u32 s7, s7, s39
    s_waitcnt vmcnt(2)
    global_load_dwordx4 v[76:79], v1, s[6:7] offset:0 nt
    s_waitcnt vmcnt(2)
    global_load_dwordx4 v[80:83], v1, s[6:7] offset:128 nt
    s_waitcnt vmcnt(2)
    global_load_dwordx4 v[84:87], v1, s[6:7] offset:256 nt
    s_cmp_eq_u32 s31, 4
    s_cselect_b64 s[38:39], s[54:55], s[56:57]
    s_add_u32 s6, s6, s38
    s_addc_u32 s7, s7, s39
    s_cbranch_vccnz L_fast12
    s_waitcnt vmcnt(2)
L_fast12:
    global_load_dwordx4 v[88:91], v1, s[6:7] offset:0 nt
    s_cbranch_vccnz L_fast13
    s_waitcnt vmcnt(2)
L_fast13:
    s_waitcnt vmcnt(3)
    global_load_dwordx4 v[92:95], v1, s[6:7] offset:128 nt
    s_cbranch_vccnz L_fast14
    s_waitcnt vmcnt(2)
L_fast14:
    s_waitcnt vmcnt(3)
    global_load_dwordx4 v[96:99], v1, s[6:7] offset:256 nt
    s_cmp_eq_u32 s31, 3
    s_cselect_b64 s[38:39], s[54:55], s[56:57]
    s_add_u32 s6, s6, s38
    s_addc_u32 s7, s7, s39
    s_cbranch_vccnz L_fast15
    s_waitcnt vmcnt(2)
L_fast15:
    s_waitcnt vmcnt(3)
    global_load_dwordx4 v[100:103], v1, s[6:7] offset:0 nt
    s_cbranch_vccnz L_fast16
    s_waitcnt vmcnt(2)
L_fast16:
    s_waitcnt vmcnt(3)
    global_load_dwordx4 v[104:107], v1, s[6:7] offset:128 nt
    s_cbranch_vccnz L_fast17
    s_waitcnt vmcnt(2)
L_fast17:
    s_waitcnt vmcnt(3)
    global_load_dwordx4 v[108:111], v1, s[6:7] offset:256 nt
    s_cmp_eq_u32 s31, 2
    s_cselect_b64 s[38:39], s[54:55], s[56:57]
    s_add_u32 s6, s6, s38
    s_addc_u32 s7, s7, s39
    v_mov_b32 v38, 0
    s_mov_b32 s41, 262144
L_lq:
    ds_read_b32 v36, v38 offset:528
    ds_read_b128 v[16:19], v3 offset:0
    ds_read_b128 v[20:23], v3 offset:128
    ds_read_b128 v[24:27], v3 offset:256
    s_waitcnt lgkmcnt(0)
    v_cmp_eq_u32 vcc, -1, v36
    s_cbranch_vccz L_lq_ok
    s_sleep 2
    s_sub_u32 s41, s41, 1
    s_cbranch_scc0 L_lq
L_lq_ok:
    s_sub_u32 s35, s2, 160
    s_cmp_lt_u32 s35, 48
    s_cselect_b64 vcc, -1, 0
    v_mov_b32 v8, 0
    v_dot2c_f32_bf16 v8, v40, v16
    v_dot2c_f32_bf16 v8, v41, v17
    v_dot2c_f32_bf16 v8, v42, v18
    v_dot2c_f32_bf16 v8, v43, v19
    v_dot2c_f32_bf16 v8, v44, v20
    v_dot2c_f32_bf16 v8, v45, v21
    v_dot2c_f32_bf16 v8, v46, v22
    v_dot2c_f32_bf16 v8, v47, v23
    v_dot2c_f32_bf16 v8, v48, v24
    v_dot2c_f32_bf16 v8, v49, v25
    v_dot2c_f32_bf16 v8, v50, v26
    v_dot2c_f32_bf16 v8, v51, v27
    s_cbranch_vccnz L_fast18
    s_waitcnt vmcnt(2)
L_fast18:
    s_waitcnt vmcnt(3)
    global_load_dwordx4 v[112:115], v1, s[6:7] offset:0 nt
    v_mov_b32 v9, 0
    v_dot2c_f32_bf16 v9, v52, v16
    v_dot2c_f32_bf16 v9, v53, v17
    v_dot2c_f32_bf16 v9, v54, v18
    v_dot2c_f32_bf16 v9, v55, v19
    v_dot2c_f32_bf16 v9, v56, v20
    v_dot2c_f32_bf16 v9, v57, v21
    v_dot2c_f32_bf16 v9, v58, v22
    v_dot2c_f32_bf16 v9, v59, v23
    v_dot2c_f32_bf16 v9, v60, v24
    v_dot2c_f32_bf16 v9, v61, v25
    v_dot2c_f32_bf16 v9, v62, v26
    v_dot2c_f32_bf16 v9, v63, v27
    s_cbranch_vccnz L_fast19
    s_waitcnt vmcnt(2)
L_fast19:
    s_waitcnt vmcnt(3)
    global_load_dwordx4 v[116:119], v1, s[6:7] offset:128 nt
    v_mov_b32 v10, 0
    v_dot2c_f32_bf16 v10, v64, v16
    v_dot2c_f32_bf16 v10, v65, v17
    v_dot2c_f32_bf16 v10, v66, v18
    v_dot2c_f32_bf16 v10, v67, v19
    v_dot2c_f32_bf16 v10, v68, v20
    v_dot2c_f32_bf16 v10, v69, v21
    v_dot2c_f32_bf16 v10, v70, v22
    v_dot2c_f32_bf16 v10, v71, v23
    v_dot2c_f32_bf16 v10, v72, v24
    v_dot2c_f32_bf16 v10, v73, v25
    v_dot2c_f32_bf16 v10, v74, v26
    v_dot2c_f32_bf16 v10, v75, v27
    s_cbranch_vccnz L_fast20
    s_waitcnt vmcnt(2)
L_fast20:
    s_waitcnt vmcnt(3)
    global_load_dwordx4 v[120:123], v1, s[6:7] offset:256 nt
    s_cmp_eq_u32 s31, 1
    s_cselect_b64 s[38:39], s[54:55], s[56:57]
    s_add_u32 s6, s6, s38
    s_addc_u32 s7, s7, s39
    v_mov_b32 v11, 0
    v_dot2c_f32_bf16 v11, v76, v16
    v_dot2c_f32_bf16 v11, v77, v17
    v_dot2c_f32_bf16 v11, v78, v18
    v_dot2c_f32_bf16 v11, v79, v19
    v_dot2c_f32_bf16 v11, v80, v20
    v_dot2c_f32_bf16 v11, v81, v21
    v_dot2c_f32_bf16 v11, v82, v22
    v_dot2c_f32_bf16 v11, v83, v23
    v_dot2c_f32_bf16 v11, v84, v24
    v_dot2c_f32_bf16 v11, v85, v25
    v_dot2c_f32_bf16 v11, v86, v26
    v_dot2c_f32_bf16 v11, v87, v27
    s_cbranch_vccnz L_fast21
    s_waitcnt vmcnt(2)
L_fast21:
    s_waitcnt vmcnt(3)
    global_load_dwordx4 v[124:127], v1, s[6:7] offset:0 nt
    v_mov_b32 v12, 0
    v_dot2c_f32_bf16 v12, v88, v16
    v_dot2c_f32_bf16 v12, v89, v17
    v_dot2c_f32_bf16 v12, v90, v18
    v_dot2c_f32_bf16 v12, v91, v19
    v_dot2c_f32_bf16 v12, v92, v20
    v_dot2c_f32_bf16 v12, v93, v21
    v_dot2c_f32_bf16 v12, v94, v22
    v_dot2c_f32_bf16 v12, v95, v23
    v_dot2c_f32_bf16 v12, v96, v24
    v_dot2c_f32_bf16 v12, v97, v25
    v_dot2c_f32_bf16 v12, v98, v26
    v_dot2c_f32_bf16 v12, v99, v27
    s_cbranch_vccnz L_fast22
    s_waitcnt vmcnt(2)
L_fast22:
    s_waitcnt vmcnt(3)
    global_load_dwordx4 v[128:131], v1, s[6:7] offset:128 nt
    v_mov_b32 v13, 0
    v_dot2c_f32_bf16 v13, v100, v16
    v_dot2c_f32_bf16 v13, v101, v17
    v_dot2c_f32_bf16 v13, v102, v18
    v_dot2c_f32_bf16 v13, v103, v19
    v_dot2c_f32_bf16 v13, v104, v20
    v_dot2c_f32_bf16 v13, v105, v21
    v_dot2c_f32_bf16 v13, v106, v22
    v_dot2c_f32_bf16 v13, v107, v23
    v_dot2c_f32_bf16 v13, v108, v24
    v_dot2c_f32_bf16 v13, v109, v25
    v_dot2c_f32_bf16 v13, v110, v26
    v_dot2c_f32_bf16 v13, v111, v27
    s_cbranch_vccnz L_fast23
    s_waitcnt vmcnt(2)
L_fast23:
    s_waitcnt vmcnt(3)
    global_load_dwordx4 v[132:135], v1, s[6:7] offset:256 nt
    s_cbranch_vccnz L_fast24
    s_waitcnt vmcnt(2)
L_fast24:
    s_waitcnt vmcnt(3)
    global_load_dwordx4 v[40:43], v1, s[8:9] offset:0 nt
    v_mov_b32 v14, 0
    v_dot2c_f32_bf16 v14, v112, v16
    v_dot2c_f32_bf16 v14, v113, v17
    v_dot2c_f32_bf16 v14, v114, v18
    v_dot2c_f32_bf16 v14, v115, v19
    v_dot2c_f32_bf16 v14, v116, v20
    v_dot2c_f32_bf16 v14, v117, v21
    v_dot2c_f32_bf16 v14, v118, v22
    v_dot2c_f32_bf16 v14, v119, v23
    v_dot2c_f32_bf16 v14, v120, v24
    v_dot2c_f32_bf16 v14, v121, v25
    v_dot2c_f32_bf16 v14, v122, v26
    v_dot2c_f32_bf16 v14, v123, v27
    s_cbranch_vccnz L_fast25
    s_waitcnt vmcnt(2)
L_fast25:
    s_waitcnt vmcnt(3)
    global_load_dwordx4 v[44:47], v1, s[8:9] offset:128 nt
    s_cbranch_vccnz L_fast26
    s_waitcnt vmcnt(2)
L_fast26:
    s_waitcnt vmcnt(3)
    global_load_dwordx4 v[48:51], v1, s[8:9] offset:256 nt
    s_cmp_eq_u32 s31, 7
    s_cselect_b64 s[38:39], s[54:55], s[56:57]
    s_add_u32 s8, s8, s38
    s_addc_u32 s9, s9, s39
    s_cbranch_vccnz L_fast27
    s_waitcnt vmcnt(2)
L_fast27:
    s_waitcnt vmcnt(3)
    global_load_dwordx4 v[52:55], v1, s[8:9] offset:0 nt
    v_mov_b32 v15, 0
    v_dot2c_f32_bf16 v15, v124, v16
    v_dot2c_f32_bf16 v15, v125, v17
    v_dot2c_f32_bf16 v15, v126, v18
    v_dot2c_f32_bf16 v15, v127, v19
    v_dot2c_f32_bf16 v15, v128, v20
    v_dot2c_f32_bf16 v15, v129, v21
    v_dot2c_f32_bf16 v15, v130, v22
    v_dot2c_f32_bf16 v15, v131, v23
    v_dot2c_f32_bf16 v15, v132, v24
    v_dot2c_f32_bf16 v15, v133, v25
    v_dot2c_f32_bf16 v15, v134, v26
    v_dot2c_f32_bf16 v15, v135, v27
    v_add_f32_dpp v8, v8, v8 quad_perm:[1,0,3,2] row_mask:0xf bank_mask:0xf
    v_add_f32_dpp v9, v9, v9 quad_perm:[1,0,3,2] row_mask:0xf bank_mask:0xf
    v_add_f32_dpp v10, v10, v10 quad_perm:[1,0,3,2] row_mask:0xf bank_mask:0xf
    v_add_f32_dpp v11, v11, v11 quad_perm:[1,0,3,2] row_mask:0xf bank_mask:0xf
    v_add_f32_dpp v12, v12, v12 quad_perm:[1,0,3,2] row_mask:0xf bank_mask:0xf
    v_add_f32_dpp v13, v13, v13 quad_perm:[1,0,3,2] row_mask:0xf bank_mask:0xf
    v_add_f32_dpp v14, v14, v14 quad_perm:[1,0,3,2] row_mask:0xf bank_mask:0xf
    v_add_f32_dpp v15, v15, v15 quad_perm:[1,0,3,2] row_mask:0xf bank_mask:0xf
    v_add_f32_dpp v8, v8, v8 quad_perm:[2,3,0,1] row_mask:0xf bank_mask:0xf
    v_add_f32_dpp v9, v9, v9 quad_perm:[2,3,0,1] row_mask:0xf bank_mask:0xf
    v_add_f32_dpp v10, v10, v10 quad_perm:[2,3,0,1] row_mask:0xf bank_mask:0xf
    v_add_f32_dpp v11, v11, v11 quad_perm:[2,3,0,1] row_mask:0xf bank_mask:0xf
    v_add_f32_dpp v12, v12, v12 quad_perm:[2,3,0,1] row_mask:0xf bank_mask:0xf
    v_add_f32_dpp v13, v13, v13 quad_perm:[2,3,0,1] row_mask:0xf bank_mask:0xf
    v_add_f32_dpp v14, v14, v14 quad_perm:[2,3,0,1] row_mask:0xf bank_mask:0xf
    v_add_f32_dpp v15, v15, v15 quad_perm:[2,3,0,1] row_mask:0xf bank_mask:0xf
    v_add_f32_dpp v8, v8, v8 row_half_mirror row_mask:0xf bank_mask:0xf
    v_add_f32_dpp v9, v9, v9 row_half_mirror row_mask:0xf bank_mask:0xf
    v_add_f32_dpp v10, v10, v10 row_half_mirror row_mask:0xf bank_mask:0xf
    v_add_f32_dpp v11, v11, v11 row_half_mirror row_mask:0xf bank_mask:0xf
    v_add_f32_dpp v12, v12, v12 row_half_mirror row_mask:0xf bank_mask:0xf
    v_add_f32_dpp v13, v13, v13 row_half_mirror row_mask:0xf bank_mask:0xf
    v_add_f32_dpp v14, v14, v14 row_half_mirror row_mask:0xf bank_mask:0xf
    v_add_f32_dpp v15, v15, v15 row_half_mirror row_mask:0xf bank_mask:0xf
    v_cvt_pk_bf16_f32 v8, 0, v8
    v_cvt_pk_bf16_f32 v9, 0, v9
    v_cvt_pk_bf16_f32 v10, 0, v10
    v_cvt_pk_bf16_f32 v11, 0, v11
    v_cvt_pk_bf16_f32 v12, 0, v12
    v_cvt_pk_bf16_f32 v13, 0, v13
    v_cvt_pk_bf16_f32 v14, 0, v14
    v_cvt_pk_bf16_f32 v15, 0, v15
    v_mul_f32 v8, 0x3d93cd3a, v8
    v_mul_f32 v9, 0x3d93cd3a, v9
    v_mul_f32 v10, 0x3d93cd3a, v10
    v_mul_f32 v11, 0x3d93cd3a, v11
    v_mul_f32 v12, 0x3d93cd3a, v12
    v_mul_f32 v13, 0x3d93cd3a, v13
    v_mul_f32 v14, 0x3d93cd3a, v14
    v_mul_f32 v15, 0x3d93cd3a, v15
    v_cvt_pk_bf16_f32 v8, 0, v8
    v_cvt_pk_bf16_f32 v9, 0, v9
    v_cvt_pk_bf16_f32 v10, 0, v10
    v_cvt_pk_bf16_f32 v11, 0, v11
    v_cvt_pk_bf16_f32 v12, 0, v12
    v_cvt_pk_bf16_f32 v13, 0, v13
    v_cvt_pk_bf16_f32 v14, 0, v14
    v_cvt_pk_bf16_f32 v15, 0, v15
    s_cbranch_vccnz L_fast28
    s_waitcnt vmcnt(2)
L_fast28:
    s_waitcnt vmcnt(3)
    global_load_dwordx4 v[56:59], v1, s[8:9] offset:128 nt
    v_max3_f32 v36, v8, v9, v10
    v_max3_f32 v36, v36, v11, v12
    v_max3_f32 v36, v36, v13, v14
    v_max_f32 v36, v36, v15
    s_nop 1
    v_max_f32_dpp v36, v36, v36 row_ror:8 row_mask:0xf bank_mask:0xf
    s_nop 1
    v_max_f32_dpp v36, v36, v36 row_bcast:15 row_mask:0xa bank_mask:0xf
    s_nop 1
    v_max_f32_dpp v36, v36, v36 row_bcast:31 row_mask:0xc bank_mask:0xf
    s_nop 0
    v_readlane_b32 s34, v36, 63
    s_nop 1
    v_subrev_f32 v16, s34, v8
    v_mul_f32 v16, 0x3fb8aa3b, v16
    v_exp_f32 v16, v16
    v_subrev_f32 v17, s34, v9
    v_mul_f32 v17, 0x3fb8aa3b, v17
    v_exp_f32 v17, v17
    v_subrev_f32 v18, s34, v10
    v_mul_f32 v18, 0x3fb8aa3b, v18
    v_exp_f32 v18, v18
    v_subrev_f32 v19, s34, v11
    v_mul_f32 v19, 0x3fb8aa3b, v19
    v_exp_f32 v19, v19
    v_subrev_f32 v20, s34, v12
    v_mul_f32 v20, 0x3fb8aa3b, v20
    v_exp_f32 v20, v20
    v_subrev_f32 v21, s34, v13
    v_mul_f32 v21, 0x3fb8aa3b, v21
    v_exp_f32 v21, v21
    v_subrev_f32 v22, s34, v14
    v_mul_f32 v22, 0x3fb8aa3b, v22
    v_exp_f32 v22, v22
    v_subrev_f32 v23, s34, v15
    v_mul_f32 v23, 0x3fb8aa3b, v23
    v_exp_f32 v23, v23
    s_lshl_b32 s35, s26, 3
    v_mov_b32 v38, s35
    v_add_f32 v37, v16, v17
    v_add_f32 v37, v37, v18
    v_add_f32 v37, v37, v19
    v_add_f32 v37, v37, v20
    v_add_f32 v37, v37, v21
    v_add_f32 v37, v37, v22
    v_add_f32 v37, v37, v23
    s_nop 1
    v_add_f32_dpp v37, v37, v37 row_ror:8 row_mask:0xf bank_mask:0xf
    s_nop 1
    v_add_f32_dpp v37, v37, v37 row_bcast:15 row_mask:0xa bank_mask:0xf
    s_nop 1
    v_add_f32_dpp v37, v37, v37 row_bcast:31 row_mask:0xc bank_mask:0xf
    s_lshl_b64 exec, 1, 63
    ds_write_b64 v38, v[36:37] offset:576
    s_mov_b64 exec, -1
    s_cbranch_vccnz L_fast29
    s_waitcnt vmcnt(2)
L_fast29:
    s_waitcnt vmcnt(3)
    global_load_dwordx4 v[60:63], v1, s[8:9] offset:256 nt
    s_cmp_eq_u32 s31, 6
    s_cselect_b64 s[38:39], s[54:55], s[56:57]
    s_add_u32 s8, s8, s38
    s_addc_u32 s9, s9, s39
    s_cbranch_vccnz L_fast30
    s_waitcnt vmcnt(2)
L_fast30:
    s_waitcnt vmcnt(3)
    global_load_dwordx4 v[64:67], v1, s[8:9] offset:0 nt
    s_cbranch_vccnz L_fast31
    s_waitcnt vmcnt(2)
L_fast31:
    s_waitcnt vmcnt(3)
    global_load_dwordx4 v[68:71], v1, s[8:9] offset:128 nt
    s_cbranch_vccnz L_fast32
    s_waitcnt vmcnt(2)
L_fast32:
    s_waitcnt vmcnt(3)
    global_load_dwordx4 v[72:75], v1, s[8:9] offset:256 nt
    s_cmp_eq_u32 s31, 5
    s_cselect_b64 s[38:39], s[54:55], s[56:57]
    s_add_u32 s8, s8, s38
    s_addc_u32 s9, s9, s39
    s_cbranch_vccnz L_fast33
    s_waitcnt vmcnt(2)
L_fast33:
    s_waitcnt vmcnt(3)
    global_load_dwordx4 v[76:79], v1, s[8:9] offset:0 nt
    s_cbranch_vccnz L_fast34
    s_waitcnt vmcnt(2)
L_fast34:
    s_waitcnt vmcnt(3)
    global_load_dwordx4 v[80:83], v1, s[8:9] offset:128 nt
    s_cbranch_vccnz L_fast35
    s_waitcnt vmcnt(2)
L_fast35:
    s_waitcnt vmcnt(3)
    global_load_dwordx4 v[84:87], v1, s[8:9] offset:256 nt
    s_cmp_eq_u32 s31, 4
    s_cselect_b64 s[38:39], s[54:55], s[56:57]
    s_add_u32 s8, s8, s38
    s_addc_u32 s9, s9, s39
    s_cbranch_vccnz L_fast36
    s_waitcnt vmcnt(2)
L_fast36:
    s_waitcnt vmcnt(3)
    global_load_dwordx4 v[88:91], v1, s[8:9] offset:0 nt
    s_cbranch_vccnz L_fast37
    s_waitcnt vmcnt(2)
L_fast37:
    s_waitcnt vmcnt(3)
    global_load_dwordx4 v[92:95], v1, s[8:9] offset:128 nt
    s_cbranch_vccnz L_fast38
    s_waitcnt vmcnt(2)
L_fast38:
    s_waitcnt vmcnt(3)
    global_load_dwordx4 v[96:99], v1, s[8:9] offset:256 nt
    s_cmp_eq_u32 s31, 3
    s_cselect_b64 s[38:39], s[54:55], s[56:57]
    s_add_u32 s8, s8, s38
    s_addc_u32 s9, s9, s39
    s_cbranch_vccnz L_fast39
    s_waitcnt vmcnt(2)
L_fast39:
    s_waitcnt vmcnt(3)
    global_load_dwordx4 v[100:103], v1, s[8:9] offset:0 nt
    s_cbranch_vccnz L_fast40
    s_waitcnt vmcnt(2)
L_fast40:
    s_waitcnt vmcnt(3)
    global_load_dwordx4 v[104:107], v1, s[8:9] offset:128 nt
    v_mov_b32 v38, 0
    s_mov_b32 s41, 262144
L_lm:
    ds_read_b128 v[136:139], v38 offset:512
    s_waitcnt lgkmcnt(0)
    v_max_u32 v36, v137, v139
    v_cmp_eq_u32 vcc, -1, v36
    s_cbranch_vccz L_lm_ok
    s_sleep 2
    s_sub_u32 s41, s41, 1
    s_cbranch_scc0 L_lm
L_lm_ok:
    s_sub_u32 s35, s2, 160
    s_cmp_lt_u32 s35, 48
    s_cselect_b64 vcc, -1, 0
    v_readfirstlane_b32 s45, v139
    v_readfirstlane_b32 s40, v138
    v_sub_f32 v8, v8, v136
    v_mul_f32 v8, 0x3fb8aa3b, v8
    v_exp_f32 v8, v8
    v_sub_f32 v9, v9, v136
    v_mul_f32 v9, 0x3fb8aa3b, v9
    v_exp_f32 v9, v9
    v_sub_f32 v10, v10, v136
    v_mul_f32 v10, 0x3fb8aa3b, v10
    v_exp_f32 v10, v10
    v_sub_f32 v11, v11, v136
    v_mul_f32 v11, 0x3fb8aa3b, v11
    v_exp_f32 v11, v11
    v_sub_f32 v12, v12, v136
    v_mul_f32 v12, 0x3fb8aa3b, v12
    v_exp_f32 v12, v12
    v_sub_f32 v13, v13, v136
    v_mul_f32 v13, 0x3fb8aa3b, v13
    v_exp_f32 v13, v13
    s_cbranch_vccnz L_fast41
    s_waitcnt vmcnt(2)
L_fast41:
    s_waitcnt vmcnt(3)
    global_load_dwordx4 v[108:111], v1, s[8:9] offset:256 nt
    s_cmp_eq_u32 s31, 2
    s_cselect_b64 s[38:39], s[54:55], s[56:57]
    s_add_u32 s8, s8, s38
    s_addc_u32 s9, s9, s39
    v_sub_f32 v14, v14, v136
    v_mul_f32 v14, 0x3fb8aa3b, v14
    v_exp_f32 v14, v14
    v_sub_f32 v15, v15, v136
    v_mul_f32 v15, 0x3fb8aa3b, v15
    v_exp_f32 v15, v15
    v_mul_f32 v8, v8, v137
    v_cvt_pk_bf16_f32 v8, v8, v8
    v_mul_f32 v9, v9, v137
    v_cvt_pk_bf16_f32 v9, v9, v9
    v_mul_f32 v10, v10, v137
    v_cvt_pk_bf16_f32 v10, v10, v10
    v_mul_f32 v11, v11, v137
    v_cvt_pk_bf16_f32 v11, v11, v11
    v_mul_f32 v12, v12, v137
    v_cvt_pk_bf16_f32 v12, v12, v12
    global_load_dwordx4 v[112:115], v1, s[8:9] offset:0 nt
    v_mul_f32 v13, v13, v137
    v_cvt_pk_bf16_f32 v13, v13, v13
    v_mul_f32 v14, v14, v137
    v_cvt_pk_bf16_f32 v14, v14, v14
    v_mul_f32 v15, v15, v137
    v_cvt_pk_bf16_f32 v15, v15, v15
    v_and_b32 v28, v4, v8
    v_and_b32 v29, v5, v8
    v_and_b32 v30, v6, v8
    v_and_b32 v31, v7, v8
    s_nop 1
    v_mfma_f32_16x16x32_bf16 v[16:19], v[28:31], v[40:43], 0
    v_mfma_f32_16x16x32_bf16 v[20:23], v[28:31], v[44:47], 0
    v_mfma_f32_16x16x32_bf16 v[24:27], v[28:31], v[48:51], 0
    v_and_b32 v32, v4, v9
    v_and_b32 v33, v5, v9
    v_and_b32 v34, v6, v9
    v_and_b32 v35, v7, v9
    s_nop 1
    v_mfma_f32_16x16x32_bf16 v[16:19], v[32:35], v[52:55], v[16:19]
    v_mfma_f32_16x16x32_bf16 v[20:23], v[32:35], v[56:59], v[20:23]
    v_mfma_f32_16x16x32_bf16 v[24:27], v[32:35], v[60:63], v[24:27]
    s_waitcnt vmcnt(4)
    global_load_dwordx4 v[116:119], v1, s[8:9] offset:128 nt
    v_and_b32 v28, v4, v10
    v_and_b32 v29, v5, v10
    v_and_b32 v30, v6, v10
    v_and_b32 v31, v7, v10
    s_nop 1
    v_mfma_f32_16x16x32_bf16 v[16:19], v[28:31], v[64:67], v[16:19]
    v_mfma_f32_16x16x32_bf16 v[20:23], v[28:31], v[68:71], v[20:23]
    v_mfma_f32_16x16x32_bf16 v[24:27], v[28:31], v[72:75], v[24:27]
    v_and_b32 v32, v4, v11
    v_and_b32 v33, v5, v11
    v_and_b32 v34, v6, v11
    v_and_b32 v35, v7, v11
    s_nop 1
    v_mfma_f32_16x16x32_bf16 v[16:19], v[32:35], v[76:79], v[16:19]
    v_mfma_f32_16x16x32_bf16 v[20:23], v[32:35], v[80:83], v[20:23]
    v_mfma_f32_16x16x32_bf16 v[24:27], v[32:35], v[84:87], v[24:27]
    v_and_b32 v28, v4, v12
    v_and_b32 v29, v5, v12
    v_and_b32 v30, v6, v12
    v_and_b32 v31, v7, v12
    s_nop 1
    v_mfma_f32_16x16x32_bf16 v[16:19], v[28:31], v[88:91], v[16:19]
    v_mfma_f32_16x16x32_bf16 v[20:23], v[28:31], v[92:95], v[20:23]
    v_mfma_f32_16x16x32_bf16 v[24:27], v[28:31], v[96:99], v[24:27]
    s_waitcnt vmcnt(4)
    global_load_dwordx4 v[120:123], v1, s[8:9] offset:256 nt
    s_cmp_eq_u32 s31, 1
    s_cselect_b64 s[38:39], s[54:55], s[56:57]
    s_add_u32 s8, s8, s38
    s_addc_u32 s9, s9, s39
    s_waitcnt vmcnt(4)
    global_load_dwordx4 v[124:127], v1, s[8:9] offset:0 nt
    s_waitcnt vmcnt(4)
    global_load_dwordx4 v[128:131], v1, s[8:9] offset:128 nt
    v_and_b32 v32, v4, v13
    v_and_b32 v33, v5, v13
    v_and_b32 v34, v6, v13
    v_and_b32 v35, v7, v13
    s_nop 1
    v_mfma_f32_16x16x32_bf16 v[16:19], v[32:35], v[100:103], v[16:19]
    v_mfma_f32_16x16x32_bf16 v[20:23], v[32:35], v[104:107], v[20:23]
    v_mfma_f32_16x16x32_bf16 v[24:27], v[32:35], v[108:111], v[24:27]
    s_waitcnt vmcnt(4)
    global_load_dwordx4 v[132:135], v1, s[8:9] offset:256 nt
    s_mov_b64 exec, 1
    v_mov_b32 v36, 1
    ds_add_u32 v38, v36 offset:540
    s_mov_b64 exec, -1
    v_and_b32 v70, 15, v0
    v_lshlrev_b32 v70, 5, v70
    v_and_b32 v39, 16, v0
    v_add_u32 v70, v70, v39
    v_lshrrev_b32 v39, 5, v0
    v_lshl_add_u32 v70, v39, 3, v70
    s_lshr_b32 s34, s26, 1
    s_mul_i32 s34, s34, 1568
    s_and_b32 s35, s26, 1
    s_mul_i32 s35, s35, 768
    s_add_u32 s34, s34, s35
    v_add_u32 v1, s34, v70
    v_and_b32 v38, 3, v0
    v_mul_u32_u24 v38, 1568, v38
    v_and_b32 v39, 60, v0
    s_lshl_b32 s34, s26, 6
    v_add3_u32 v38, v38, v39, s34
    s_lshl_b32 s35, s27, 13
    s_lshl_b32 s34, s26, 11
    s_add_u32 s35, s35, s34
    s_lshl_b32 s34, s28, 4
    s_add_u32 s35, s35, s34
    s_add_u32 s35, s35, 303104
    v_lshl_add_u32 v37, v39, 5, s35
    v_mov_b32 v75, s40
    s_cmp_lt_u32 s2, 160
    s_cbranch_scc1 L_wo
    s_cmp_lt_u32 s2, 208
    s_cbranch_scc1 L_ffn
    v_mov_b32 v36, 1
    v_mov_b32 v39, 0
    s_waitcnt lgkmcnt(0)
    v_and_b32 v28, v4, v14
    v_and_b32 v29, v5, v14
    v_and_b32 v30, v6, v14
    v_and_b32 v31, v7, v14
    s_nop 1
    v_mfma_f32_16x16x32_bf16 v[16:19], v[28:31], v[112:115], v[16:19]
    s_waitcnt vmcnt(4)
    v_mfma_f32_16x16x32_bf16 v[20:23], v[28:31], v[116:119], v[20:23]
    s_waitcnt vmcnt(3)
    v_mfma_f32_16x16x32_bf16 v[24:27], v[28:31], v[120:123], v[24:27]
    v_and_b32 v32, v4, v15
    v_and_b32 v33, v5, v15
    v_and_b32 v34, v6, v15
    v_and_b32 v35, v7, v15
    s_waitcnt vmcnt(2)
    s_nop 0
    v_mfma_f32_16x16x32_bf16 v[16:19], v[32:35], v[124:127], v[16:19]
    s_waitcnt vmcnt(1)
    v_mfma_f32_16x16x32_bf16 v[20:23], v[32:35], v[128:131], v[20:23]
    s_waitcnt vmcnt(0)
    v_mfma_f32_16x16x32_bf16 v[24:27], v[32:35], v[132:135], v[24:27]
    s_cmp_lt_u32 s26, 4
    s_mov_b32 s41, 262144
    s_nop 1
    v_permlane32_swap_b32 v16, v18
    v_permlane32_swap_b32 v17, v19
    v_permlane32_swap_b32 v20, v22
    v_permlane32_swap_b32 v21, v23
    v_add_f32_dpp v16, v18, v16 row_ror:8 row_mask:0xf bank_mask:0x3
    v_add_f32_dpp v17, v19, v17 row_ror:8 row_mask:0xf bank_mask:0x3
    v_permlane32_swap_b32 v24, v26
    v_add_f32_dpp v16, v20, v22 row_ror:8 row_mask:0xf bank_mask:0xc
    v_add_f32_dpp v17, v21, v23 row_ror:8 row_mask:0xf bank_mask:0xc
    v_permlane32_swap_b32 v25, v27
    ds_write_b64 v1, v[16:17] offset:4096
    v_add_f32_dpp v24, v26, v24 row_ror:8 row_mask:0xf bank_mask:0xf
    v_add_f32_dpp v25, v27, v25 row_ror:8 row_mask:0xf bank_mask:0xf
    s_mov_b32 exec_lo, 0x00ff00ff
    s_mov_b32 exec_hi, 0x00ff00ff
    ds_write_b64 v1, v[24:25] offset:4608
    s_mov_b64 exec, 1
    ds_add_u32 v39, v36 offset:532
    s_mov_b64 exec, -1
    s_cbranch_scc0 L_pub_none
L_pc_none:
    ds_read_b32 v36, v39 offset:532
    ds_read2st64_b32 v[76:77], v38 offset0:16 offset1:19
    ds_read2st64_b32 v[78:79], v38 offset0:17 offset1:20
    ds_read2st64_b32 v[80:81], v38 offset0:18 offset1:21
    s_sub_u32 s41, s41, 1
    s_cbranch_scc1 L_pub_none
    s_waitcnt lgkmcnt(3)
    v_cmp_ne_u32 vcc, 7, v36
    s_cbranch_vccnz L_pc_none
    s_cmp_eq_u32 s45, 1
    s_waitcnt lgkmcnt(0)
    v_add_f32 v72, v76, v77
    v_add_f32 v73, v78, v79
    v_add_f32 v74, v80, v81
    v_add_f32_dpp v72, v72, v72 quad_perm:[1,0,3,2] row_mask:0xf bank_mask:0xf
    v_add_f32_dpp v73, v73, v73 quad_perm:[1,0,3,2] row_mask:0xf bank_mask:0xf
    v_add_f32_dpp v74, v74, v74 quad_perm:[1,0,3,2] row_mask:0xf bank_mask:0xf
    v_add_f32_dpp v72, v72, v72 quad_perm:[2,3,0,1] row_mask:0xf bank_mask:0xf
    v_add_f32_dpp v73, v73, v73 quad_perm:[2,3,0,1] row_mask:0xf bank_mask:0xf
    v_add_f32_dpp v74, v74, v74 quad_perm:[2,3,0,1] row_mask:0xf bank_mask:0xf
    s_mov_b32 exec_lo, 0x11111111
    s_mov_b32 exec_hi, 0x11111111
    s_cbranch_scc0 L_far_none
    global_store_dwordx4 v37, v[72:75], s[24:25]
L_pub_none:
    s_mov_b64 exec, -1
    s_endpgm
L_far_none:
    global_store_dwordx4 v37, v[72:75], s[24:25] sc1
    s_branch L_pub_none
.p2align 12
L_wo:
    s_lshr_b32 s42, s27, 1
    s_and_b32 s43, s30, 1
    s_lshl1_add_u32 s43, s28, s43
    s_mul_i32 s34, s26, 6144
    s_add_u32 s34, s34, 20480
    v_lshl_add_u32 v164, v0, 4, s34
    s_lshl3_add_u32 s34, s42, s26
    s_lshl_b32 s34, s34, 11
    s_add_u32 s34, s34, 303104
    v_lshl_add_u32 v160, v0, 4, s34
    s_lshl_b32 s34, s26, 8
    v_add_u32 v161, s34, v70
    v_lshlrev_b32 v162, 2, v0
    s_and_b32 s34, s42, 1
    s_mul_i32 s34, s34, 2560
    s_lshl_b32 s35, s43, 8
    s_add_u32 s34, s34, s35
    s_lshl_b32 s35, s29, 14
    s_add_u32 s34, s34, s35
    s_add_u32 s34, s34, 573440
    v_add_u32 v163, s34, v162
    v_add_u32 v166, 8192, v163
    v_mov_b32 v36, 1
    v_mov_b32 v39, 0
    s_waitcnt lgkmcnt(0)
    v_and_b32 v28, v4, v14
    v_and_b32 v29, v5, v14
    v_and_b32 v30, v6, v14
    v_and_b32 v31, v7, v14
    s_nop 1
    v_mfma_f32_16x16x32_bf16 v[16:19], v[28:31], v[112:115], v[16:19]
    s_waitcnt vmcnt(4)
    v_mfma_f32_16x16x32_bf16 v[20:23], v[28:31], v[116:119], v[20:23]
    s_waitcnt vmcnt(3)
    v_mfma_f32_16x16x32_bf16 v[24:27], v[28:31], v[120:123], v[24:27]
    v_and_b32 v32, v4, v15
    v_and_b32 v33, v5, v15
    v_and_b32 v34, v6, v15
    v_and_b32 v35, v7, v15
    s_waitcnt vmcnt(2)
    s_nop 0
    v_mfma_f32_16x16x32_bf16 v[16:19], v[32:35], v[124:127], v[16:19]
    s_waitcnt vmcnt(1)
    v_mfma_f32_16x16x32_bf16 v[20:23], v[32:35], v[128:131], v[20:23]
    s_waitcnt vmcnt(0)
    v_mfma_f32_16x16x32_bf16 v[24:27], v[32:35], v[132:135], v[24:27]
    s_cmp_lt_u32 s26, 4
    s_mov_b32 s41, 262144
    s_nop 1
    v_permlane32_swap_b32 v16, v18
    v_permlane32_swap_b32 v17, v19
    v_permlane32_swap_b32 v20, v22
    v_permlane32_swap_b32 v21, v23
    v_add_f32_dpp v16, v18, v16 row_ror:8 row_mask:0xf bank_mask:0x3
    v_add_f32_dpp v17, v19, v17 row_ror:8 row_mask:0xf bank_mask:0x3
    v_permlane32_swap_b32 v24, v26
    v_add_f32_dpp v16, v20, v22 row_ror:8 row_mask:0xf bank_mask:0xc
    v_add_f32_dpp v17, v21, v23 row_ror:8 row_mask:0xf bank_mask:0xc
    v_permlane32_swap_b32 v25, v27
    ds_write_b64 v1, v[16:17] offset:4096
    v_add_f32_dpp v24, v26, v24 row_ror:8 row_mask:0xf bank_mask:0xf
    v_add_f32_dpp v25, v27, v25 row_ror:8 row_mask:0xf bank_mask:0xf
    s_mov_b32 exec_lo, 0x00ff00ff
    s_mov_b32 exec_hi, 0x00ff00ff
    ds_write_b64 v1, v[24:25] offset:4608
    s_mov_b64 exec, 1
    ds_add_u32 v39, v36 offset:532
    s_mov_b64 exec, -1
    s_cbranch_scc0 L_pub_wo
L_pc_wo:
    ds_read_b32 v36, v39 offset:532
    ds_read2st64_b32 v[76:77], v38 offset0:16 offset1:19
    ds_read2st64_b32 v[78:79], v38 offset0:17 offset1:20
    ds_read2st64_b32 v[80:81], v38 offset0:18 offset1:21
    s_sub_u32 s41, s41, 1
    s_cbranch_scc1 L_pub_wo
    s_waitcnt lgkmcnt(3)
    v_cmp_ne_u32 vcc, 7, v36
    s_cbranch_vccnz L_pc_wo
    s_cmp_eq_u32 s45, 1
    s_waitcnt lgkmcnt(0)
    v_add_f32 v72, v76, v77
    v_add_f32 v73, v78, v79
    v_add_f32 v74, v80, v81
    v_add_f32_dpp v72, v72, v72 quad_perm:[1,0,3,2] row_mask:0xf bank_mask:0xf
    v_add_f32_dpp v73, v73, v73 quad_perm:[1,0,3,2] row_mask:0xf bank_mask:0xf
    v_add_f32_dpp v74, v74, v74 quad_perm:[1,0,3,2] row_mask:0xf bank_mask:0xf
    v_add_f32_dpp v72, v72, v72 quad_perm:[2,3,0,1] row_mask:0xf bank_mask:0xf
    v_add_f32_dpp v73, v73, v73 quad_perm:[2,3,0,1] row_mask:0xf bank_mask:0xf
    v_add_f32_dpp v74, v74, v74 quad_perm:[2,3,0,1] row_mask:0xf bank_mask:0xf
    s_mov_b32 exec_lo, 0x11111111
    s_mov_b32 exec_hi, 0x11111111
    s_cbranch_scc0 L_far_wo
    global_store_dwordx4 v37, v[72:75], s[24:25]
L_pub_wo:
    s_mov_b64 exec, -1
    s_mov_b32 s41, 262144
    global_load_dwordx4 v[88:91], v160, s[24:25] sc1
    global_load_dwordx4 v[92:95], v160, s[24:25] offset:1024 sc1
    s_barrier
    ds_read_b128 v[136:139], v164 offset:0
    ds_read_b128 v[140:143], v164 offset:1024
    ds_read_b128 v[144:147], v164 offset:2048
    ds_read_b128 v[148:151], v164 offset:3072
    ds_read_b128 v[152:155], v164 offset:4096
    ds_read_b128 v[156:159], v164 offset:5120
    s_branch L_po_go
L_po:
    s_sleep 1
    global_load_dwordx4 v[88:91], v160, s[24:25] sc1
    global_load_dwordx4 v[92:95], v160, s[24:25] offset:1024 sc1
L_po_go:
    s_sub_u32 s41, s41, 1
    s_cbranch_scc1 L_po_giveup
    s_waitcnt vmcnt(0)
    v_cmp_ne_u32 vcc, s40, v91
    v_cmp_ne_u32 s[46:47], s40, v95
    s_nop 0
    s_or_b64 exec, vcc, s[46:47]
    s_cbranch_scc1 L_po
L_po_ok:
    s_mov_b64 exec, -1
    v_add_f32_dpp v88, v88, v88 quad_perm:[1,0,3,2] row_mask:0xf bank_mask:0xf
    v_add_f32_dpp v89, v89, v89 quad_perm:[1,0,3,2] row_mask:0xf bank_mask:0xf
    v_add_f32_dpp v90, v90, v90 quad_perm:[1,0,3,2] row_mask:0xf bank_mask:0xf
    v_add_f32_dpp v92, v92, v92 quad_perm:[1,0,3,2] row_mask:0xf bank_mask:0xf
    v_add_f32_dpp v93, v93, v93 quad_perm:[1,0,3,2] row_mask:0xf bank_mask:0xf
    v_add_f32_dpp v94, v94, v94 quad_perm:[1,0,3,2] row_mask:0xf bank_mask:0xf
    v_add_f32_dpp v88, v88, v88 quad_perm:[2,3,0,1] row_mask:0xf bank_mask:0xf
    v_add_f32_dpp v89, v89, v89 quad_perm:[2,3,0,1] row_mask:0xf bank_mask:0xf
    v_add_f32_dpp v90, v90, v90 quad_perm:[2,3,0,1] row_mask:0xf bank_mask:0xf
    v_add_f32_dpp v92, v92, v92 quad_perm:[2,3,0,1] row_mask:0xf bank_mask:0xf
    v_add_f32_dpp v93, v93, v93 quad_perm:[2,3,0,1] row_mask:0xf bank_mask:0xf
    v_add_f32_dpp v94, v94, v94 quad_perm:[2,3,0,1] row_mask:0xf bank_mask:0xf
    v_add_f32_dpp v88, v88, v88 row_half_mirror row_mask:0xf bank_mask:0xf
    v_add_f32_dpp v89, v89, v89 row_half_mirror row_mask:0xf bank_mask:0xf
    v_add_f32_dpp v90, v90, v90 row_half_mirror row_mask:0xf bank_mask:0xf
    v_add_f32_dpp v92, v92, v92 row_half_mirror row_mask:0xf bank_mask:0xf
    v_add_f32_dpp v93, v93, v93 row_half_mirror row_mask:0xf bank_mask:0xf
    v_add_f32_dpp v94, v94, v94 row_half_mirror row_mask:0xf bank_mask:0xf
    v_cvt_pk_bf16_f32 v88, v88, v88
    v_cvt_pk_bf16_f32 v89, v89, v89
    v_cvt_pk_bf16_f32 v90, v90, v90
    v_cvt_pk_bf16_f32 v92, v92, v92
    v_cvt_pk_bf16_f32 v93, v93, v93
    v_cvt_pk_bf16_f32 v94, v94, v94
    s_waitcnt lgkmcnt(0)
    v_and_b32 v28, v4, v88
    v_and_b32 v29, v5, v88
    v_and_b32 v30, v6, v88
    v_and_b32 v31, v7, v88
    v_and_b32 v32, v4, v89
    v_and_b32 v33, v5, v89
    v_and_b32 v34, v6, v89
    v_and_b32 v35, v7, v89
    v_mfma_f32_16x16x32_bf16 v[16:19], v[28:31], v[136:139], 0
    v_and_b32 v28, v4, v90
    v_and_b32 v29, v5, v90
    v_and_b32 v30, v6, v90
    v_and_b32 v31, v7, v90
    v_mfma_f32_16x16x32_bf16 v[16:19], v[32:35], v[140:143], v[16:19]
    v_and_b32 v32, v4, v92
    v_and_b32 v33, v5, v92
    v_and_b32 v34, v6, v92
    v_and_b32 v35, v7, v92
    v_mfma_f32_16x16x32_bf16 v[16:19], v[28:31], v[144:147], v[16:19]
    v_and_b32 v28, v4, v93
    v_and_b32 v29, v5, v93
    v_and_b32 v30, v6, v93
    v_and_b32 v31, v7, v93
    v_mfma_f32_16x16x32_bf16 v[16:19], v[32:35], v[148:151], v[16:19]
    v_and_b32 v32, v4, v94
    v_and_b32 v33, v5, v94
    v_and_b32 v34, v6, v94
    v_and_b32 v35, v7, v94
    v_mfma_f32_16x16x32_bf16 v[16:19], v[28:31], v[152:155], v[16:19]
    s_nop 0
    v_mfma_f32_16x16x32_bf16 v[16:19], v[32:35], v[156:159], v[16:19]
    s_cmp_eq_u32 s26, 0
    s_nop 6
    v_permlane32_swap_b32 v16, v18
    v_permlane32_swap_b32 v17, v19
    s_nop 0
    v_add_f32_dpp v16, v18, v16 row_ror:8 row_mask:0xf bank_mask:0xf
    v_add_f32_dpp v17, v19, v17 row_ror:8 row_mask:0xf bank_mask:0xf
    s_mov_b32 exec_lo, 0x00ff00ff
    s_mov_b32 exec_hi, 0x00ff00ff
    ds_write_b64 v161, v[16:17] offset:12288
    s_mov_b64 exec, -1
    s_waitcnt lgkmcnt(0)
    s_barrier
    s_cbranch_scc0 L_fin
    ds_read2st64_b32 v[72:73], v162 offset0:48 offset1:49
    ds_read2st64_b32 v[74:75], v162 offset0:50 offset1:51
    ds_read2st64_b32 v[76:77], v162 offset0:52 offset1:53
    ds_read2st64_b32 v[78:79], v162 offset0:54 offset1:55
    s_waitcnt lgkmcnt(2)
    v_pk_add_f32 v[72:73], v[72:73], v[74:75]
    s_waitcnt lgkmcnt(0)
    v_pk_add_f32 v[76:77], v[76:77], v[78:79]
    v_pk_add_f32 v[72:73], v[72:73], v[76:77]
    v_add_f32 v72, v72, v73
    global_store_dword v163, v72, s[24:25] sc1
    global_store_dword v166, v72, s[24:25] sc1
L_fin:
    s_endpgm
L_po_giveup:
    s_waitcnt vmcnt(0)
    s_branch L_po_ok
L_far_wo:
    global_store_dwordx4 v37, v[72:75], s[24:25] sc1
    s_branch L_pub_wo
L_w8_rest:
    s_sub_u32 s42, s2, 160
    s_and_b32 s43, s40, -2
    s_cmp_lt_u32 s42, 48
    s_cbranch_scc1 L_w8_ffn
    s_cmp_lt_u32 s42, 64
    s_cbranch_scc0 L_helper_done
    s_sub_u32 s35, s30, 26
    s_lshl1_add_u32 s35, s29, s35
    s_lshl_b32 s34, s35, 13
    s_add_u32 s34, s34, 576512
    s_add_u32 s35, s35, 20
    s_mov_b32 s36, s43
    v_lshl_add_u32 v36, v0, 4, s34
    v_mov_b32 v12, -1
    v_mov_b32 v13, -1
    v_mov_b32 v14, -1
    v_mov_b32 v15, -1
    global_store_dwordx4 v36, v[12:15], s[24:25] offset:-3072 sc1
    global_store_dwordx4 v36, v[12:15], s[24:25] offset:-2048 sc1
    global_store_dwordx4 v36, v[12:15], s[24:25] offset:-1024 sc1
    global_store_dwordx4 v36, v[12:15], s[24:25] offset:0 sc1
    global_store_dwordx4 v36, v[12:15], s[24:25] offset:1024 sc1
    s_lshl_b32 s35, s35, 5
    s_add_u32 s35, s35, 565248
    v_mov_b32 v36, s35
    v_mov_b32 v37, s36
    s_waitcnt vmcnt(0)
    s_mov_b64 exec, 1
    global_store_dword v36, v37, s[24:25] sc1
    s_mov_b64 exec, -1
    s_endpgm
L_w8_ffn:
    s_mov_b32 s53, 0
    s_waitcnt lgkmcnt(0)
    s_and_b32 s34, s42, 3
    s_mul_i32 s34, s34, 81920
    s_add_u32 s34, s34, 710656
    s_lshr_b32 s35, s42, 2
    s_lshl_b32 s35, s35, 7
    s_add_u32 s36, s35, 0
    s_and_b32 s36, s36, 2047
    s_add_u32 s36, s36, s34
    s_add_u32 s54, s36, 0
    s_add_u32 s55, s54, 8192
    s_add_u32 s36, s35, 384
    s_and_b32 s36, s36, 2047
    s_add_u32 s36, s36, s34
    s_add_u32 s56, s36, 16384
    s_add_u32 s57, s56, 8192
    s_add_u32 s36, s35, 768
    s_and_b32 s36, s36, 2047
    s_add_u32 s36, s36, s34
    s_add_u32 s58, s36, 32768
    s_add_u32 s59, s58, 8192
    s_add_u32 s36, s35, 1152
    s_and_b32 s36, s36, 2047
    s_add_u32 s36, s36, s34
    s_add_u32 s60, s36, 49152
    s_add_u32 s61, s60, 8192
    s_add_u32 s36, s35, 1536
    s_and_b32 s36, s36, 2047
    s_add_u32 s36, s36, s34
    s_add_u32 s62, s36, 65536
    s_add_u32 s63, s62, 8192
    s_load_dword s44, s[24:25], s54 glc
    s_load_dword s44, s[24:25], s55 glc
    s_load_dword s44, s[24:25], s56 glc
    s_load_dword s44, s[24:25], s57 glc
    s_load_dword s44, s[24:25], s58 glc
    s_load_dword s44, s[24:25], s59 glc
    s_load_dword s44, s[24:25], s60 glc
    s_load_dword s44, s[24:25], s61 glc
    s_load_dword s44, s[24:25], s62 glc
    s_load_dword s44, s[24:25], s63 glc
    s_mov_b32 s36, -1
    s_mov_b32 s37, -1
    s_waitcnt lgkmcnt(0)
    s_memtime s[46:47]
    s_waitcnt lgkmcnt(0)
    s_load_dword s44, s[24:25], s54 glc
    s_waitcnt lgkmcnt(0)
    s_memtime s[48:49]
    s_waitcnt lgkmcnt(0)
    s_load_dword s44, s[24:25], s55 glc
    s_sub_u32 s45, s48, s46
    s_min_u32 s36, s36, s45
    s_waitcnt lgkmcnt(0)
    s_memtime s[46:47]
    s_waitcnt lgkmcnt(0)
    s_load_dword s44, s[24:25], s56 glc
    s_sub_u32 s45, s46, s48
    s_min_u32 s37, s37, s45
    s_waitcnt lgkmcnt(0)
    s_memtime s[48:49]
    s_waitcnt lgkmcnt(0)
    s_load_dword s44, s[24:25], s57 glc
    s_sub_u32 s45, s48, s46
    s_min_u32 s36, s36, s45
    s_waitcnt lgkmcnt(0)
    s_memtime s[46:47]
    s_waitcnt lgkmcnt(0)
    s_load_dword s44, s[24:25], s58 glc
    s_sub_u32 s45, s46, s48
    s_min_u32 s37, s37, s45
    s_waitcnt lgkmcnt(0)
    s_memtime s[48:49]
    s_waitcnt lgkmcnt(0)
    s_load_dword s44, s[24:25], s59 glc
    s_sub_u32 s45, s48, s46
    s_min_u32 s36, s36, s45
    s_waitcnt lgkmcnt(0)
    s_memtime s[46:47]
    s_waitcnt lgkmcnt(0)
    s_load_dword s44, s[24:25], s60 glc
    s_sub_u32 s45, s46, s48
    s_min_u32 s37, s37, s45
    s_waitcnt lgkmcnt(0)
    s_memtime s[48:49]
    s_waitcnt lgkmcnt(0)
    s_load_dword s44, s[24:25], s61 glc
    s_sub_u32 s45, s48, s46
    s_min_u32 s36, s36, s45
    s_waitcnt lgkmcnt(0)
    s_memtime s[46:47]
    s_waitcnt lgkmcnt(0)
    s_load_dword s44, s[24:25], s62 glc
    s_sub_u32 s45, s46, s48
    s_min_u32 s37, s37, s45
    s_waitcnt lgkmcnt(0)
    s_memtime s[48:49]
    s_waitcnt lgkmcnt(0)
    s_load_dword s44, s[24:25], s63 glc
    s_sub_u32 s45, s48, s46
    s_min_u32 s36, s36, s45
    s_waitcnt lgkmcnt(0)
    s_memtime s[46:47]
    s_waitcnt lgkmcnt(0)
    s_sub_u32 s45, s46, s48
    s_min_u32 s37, s37, s45
    s_cmp_lt_u32 s37, s36
    s_cselect_b32 s53, 1, 0
    v_mov_b32 v8, s53
    ds_write_b32 v10, v8 offset:536
    s_cmp_lt_u32 s42, 20
    s_cbranch_scc0 L_helper_done
    s_lshl1_add_u32 s34, s42, s53
    s_lshl_b32 s34, s34, 13
    s_add_u32 s34, s34, 707584
    s_mov_b32 s35, s42
    s_or_b32 s36, s43, s53
    v_lshl_add_u32 v36, v0, 4, s34
    v_mov_b32 v12, -1
    v_mov_b32 v13, -1
    v_mov_b32 v14, -1
    v_mov_b32 v15, -1
    global_store_dwordx4 v36, v[12:15], s[24:25] offset:-3072 sc1
    global_store_dwordx4 v36, v[12:15], s[24:25] offset:-2048 sc1
    global_store_dwordx4 v36, v[12:15], s[24:25] offset:-1024 sc1
    global_store_dwordx4 v36, v[12:15], s[24:25] offset:0 sc1
    global_store_dwordx4 v36, v[12:15], s[24:25] offset:1024 sc1
    global_store_dwordx4 v36, v[12:15], s[24:25] offset:2048 sc1
    s_lshl_b32 s35, s35, 5
    s_add_u32 s35, s35, 565248
    v_mov_b32 v36, s35
    v_mov_b32 v37, s36
    s_waitcnt vmcnt(0)
    s_mov_b64 exec, 1
    global_store_dword v36, v37, s[24:25] sc1
    s_mov_b64 exec, -1
    s_endpgm
L_w9:
    s_load_dword s40, s[24:25], 0
    v_lshlrev_b32 v1, 4, v0
    s_getpc_b64 s[34:35]
L_pc:
    s_sub_u32 s34, s34, L_pc-L_start
    s_subb_u32 s35, s35, 0
    s_lshl_b32 s36, s30, 10
    v_add_u32 v36, s36, v1
    v_cmp_gt_u32 vcc, L_code_end-L_start-15, v36
    s_nop 0
    s_and_saveexec_b64 s[36:37], vcc
    s_cbranch_execz L_nopf
    global_load_dwordx4 v[40:43], v36, s[34:35]
L_nopf:
    s_mov_b64 exec, -1
    s_lshr_b32 s34, s27, 1
    s_lshl_b32 s34, s34, 14
    s_add_u32 s34, s34, 8204
    v_lshl_add_u32 v12, v15, 10, s34
    s_lshl_b32 s34, s27, 10
    s_add_u32 s34, s34, 270336
    v_add_u32 v13, s34, v1
    s_lshl_b32 s35, s28, 7
    s_add_u32 s34, s34, s35
    v_add_u32 v15, s34, v1
    v_lshrrev_b32 v14, 1, v3
    v_mov_b32 v21, 0
    s_waitcnt lgkmcnt(0)
    s_mul_i32 s40, s40, 0x9e3779b1
    s_add_u32 s40, s40, 0x7f4a7c15
    s_getreg_b32 s43, hwreg(HW_REG_XCC_ID, 0, 4)
    s_and_b32 s44, s40, 0xfffffff0
    s_or_b32 s43, s43, s44
    v_mov_b32 v10, s40
    v_mov_b32 v11, s40
    s_mov_b32 s41, 262144
L_lf:
    ds_read_b32 v8, v21 offset:528
    s_waitcnt lgkmcnt(0)
    v_cmp_eq_u32 vcc, -1, v8
    s_cbranch_vccz L_lf_ok
    s_sleep 8
    s_sub_u32 s41, s41, 1
    s_cbranch_scc0 L_lf
L_lf_ok:
    s_mov_b32 s41, 6
L_pf:
    global_load_dword v16, v12, s[24:25] sc1
    s_waitcnt vmcnt(0)
    v_cmp_ne_u32 vcc, s43, v16
    s_cbranch_vccz L_pf_ok
    s_sleep 8
    s_sub_u32 s41, s41, 1
    s_cbranch_scc0 L_pf
L_pf_ok:
    s_cmp_eq_u64 vcc, 0
    s_cselect_b32 s47, 1, 0
    s_mov_b32 s41, 262144
L_pl:
    ds_read_b64 v[8:9], v14 offset:576
    s_waitcnt lgkmcnt(0)
    v_max_u32 v20, v8, v9
    v_cmp_eq_u32 vcc, -1, v20
    s_cbranch_vccz L_pl_ok
    s_sleep 2
    s_sub_u32 s41, s41, 1
    s_cbranch_scc0 L_pl
L_pl_ok:
    s_mov_b64 exec, 0xff
    s_cmp_eq_u32 s47, 1
    s_cbranch_scc1 L_ml_near
    global_store_dwordx4 v15, v[8:11], s[24:25] sc1
    s_branch L_ml_sent
L_ml_near:
    global_store_dwordx4 v15, v[8:11], s[24:25]
L_ml_sent:
    s_mov_b64 exec, -1
    s_mov_b32 s41, 262144
L_pm:
    global_load_dwordx4 v[16:19], v13, s[24:25] sc1
    s_waitcnt vmcnt(0)
    v_cmp_ne_u32 vcc, s40, v18
    s_cbranch_vccz L_pm_ok
    s_sleep 1
    s_sub_u32 s41, s41, 1
    s_cbranch_scc0 L_pm
L_pm_ok:
    v_mov_b32 v10, v16
    s_nop 1
    v_max_f32_dpp v10, v10, v10 quad_perm:[1,0,3,2] row_mask:0xf bank_mask:0xf
    s_nop 1
    v_max_f32_dpp v10, v10, v10 quad_perm:[2,3,0,1] row_mask:0xf bank_mask:0xf
    s_nop 1
    v_max_f32_dpp v10, v10, v10 row_half_mirror row_mask:0xf bank_mask:0xf
    s_nop 1
    v_max_f32_dpp v10, v10, v10 row_ror:8 row_mask:0xf bank_mask:0xf
    s_nop 1
    v_max_f32_dpp v10, v10, v10 row_bcast:15 row_mask:0xa bank_mask:0xf
    s_nop 1
    v_max_f32_dpp v10, v10, v10 row_bcast:31 row_mask:0xc bank_mask:0xf
    s_nop 0
    v_readlane_b32 s34, v10, 63
    s_nop 1
    v_subrev_f32 v8, s34, v16
    v_mul_f32 v8, 0x3fb8aa3b, v8
    v_exp_f32 v8, v8
    s_nop 0
    v_mul_f32 v9, v8, v17
    s_nop 1
    v_add_f32_dpp v9, v9, v9 quad_perm:[1,0,3,2] row_mask:0xf bank_mask:0xf
    s_nop 1
    v_add_f32_dpp v9, v9, v9 quad_perm:[2,3,0,1] row_mask:0xf bank_mask:0xf
    s_nop 1
    v_add_f32_dpp v9, v9, v9 row_half_mirror row_mask:0xf bank_mask:0xf
    s_nop 1
    v_add_f32_dpp v9, v9, v9 row_ror:8 row_mask:0xf bank_mask:0xf
    s_nop 1
    v_add_f32_dpp v9, v9, v9 row_bcast:15 row_mask:0xa bank_mask:0xf
    s_nop 1
    v_add_f32_dpp v9, v9, v9 row_bcast:31 row_mask:0xc bank_mask:0xf
    v_rcp_f32 v9, v9
    v_mov_b32 v8, s34
    v_mov_b32 v10, s40
    v_mov_b32 v11, s47
    s_lshl_b64 exec, 1, 63
    ds_write_b128 v21, v[8:11] offset:512
    s_mov_b64 exec, -1
    s_cmp_lt_u32 s2, 160
    s_cbranch_scc0 L_helper_done
    s_lshl_b32 s34, s29, 6
    s_add_u32 s34, s34, 565888
    v_and_b32 v12, 1, v0
    v_lshl_add_u32 v12, v12, 5, s34
    s_and_b32 s43, s40, -2
    s_mov_b32 s41, 262144
L_py9:
    global_load_dword v16, v12, s[24:25] sc1
    s_waitcnt vmcnt(0)
    v_cmp_ne_u32 vcc, s43, v16
    s_cbranch_vccz L_py9_ok
    s_sleep 8
    s_sub_u32 s41, s41, 1
    s_cbranch_scc0 L_py9
L_py9_ok:
L_helper_done:
    s_endpgm
.p2align 12
L_ffn:
    v_mov_b32 v36, 1
    v_mov_b32 v39, 0
    s_waitcnt lgkmcnt(0)
    v_and_b32 v28, v4, v14
    v_and_b32 v29, v5, v14
    v_and_b32 v30, v6, v14
    v_and_b32 v31, v7, v14
    s_nop 1
    v_mfma_f32_16x16x32_bf16 v[16:19], v[28:31], v[112:115], v[16:19]
    s_waitcnt vmcnt(4)
    v_mfma_f32_16x16x32_bf16 v[20:23], v[28:31], v[116:119], v[20:23]
    s_waitcnt vmcnt(3)
    v_mfma_f32_16x16x32_bf16 v[24:27], v[28:31], v[120:123], v[24:27]
    v_and_b32 v32, v4, v15
    v_and_b32 v33, v5, v15
    v_and_b32 v34, v6, v15
    v_and_b32 v35, v7, v15
    s_waitcnt vmcnt(2)
    s_nop 0
    v_mfma_f32_16x16x32_bf16 v[16:19], v[32:35], v[124:127], v[16:19]
    s_waitcnt vmcnt(1)
    v_mfma_f32_16x16x32_bf16 v[20:23], v[32:35], v[128:131], v[20:23]
    s_waitcnt vmcnt(0)
    v_mfma_f32_16x16x32_bf16 v[24:27], v[32:35], v[132:135], v[24:27]
    s_cmp_lt_u32 s26, 4
    s_mov_b32 s41, 262144
    s_nop 1
    v_permlane32_swap_b32 v16, v18
    v_permlane32_swap_b32 v17, v19
    v_permlane32_swap_b32 v20, v22
    v_permlane32_swap_b32 v21, v23
    v_add_f32_dpp v16, v18, v16 row_ror:8 row_mask:0xf bank_mask:0x3
    v_add_f32_dpp v17, v19, v17 row_ror:8 row_mask:0xf bank_mask:0x3
    v_permlane32_swap_b32 v24, v26
    v_add_f32_dpp v16, v20, v22 row_ror:8 row_mask:0xf bank_mask:0xc
    v_add_f32_dpp v17, v21, v23 row_ror:8 row_mask:0xf bank_mask:0xc
    v_permlane32_swap_b32 v25, v27
    ds_write_b64 v1, v[16:17] offset:4096
    v_add_f32_dpp v24, v26, v24 row_ror:8 row_mask:0xf bank_mask:0xf
    v_add_f32_dpp v25, v27, v25 row_ror:8 row_mask:0xf bank_mask:0xf
    s_mov_b32 exec_lo, 0x00ff00ff
    s_mov_b32 exec_hi, 0x00ff00ff
    ds_write_b64 v1, v[24:25] offset:4608
    s_mov_b64 exec, 1
    ds_add_u32 v39, v36 offset:532
    s_mov_b64 exec, -1
    s_cbranch_scc0 L_pub_ffn
L_pc_ffn:
    ds_read_b32 v36, v39 offset:532
    ds_read2st64_b32 v[76:77], v38 offset0:16 offset1:19
    ds_read2st64_b32 v[78:79], v38 offset0:17 offset1:20
    ds_read2st64_b32 v[80:81], v38 offset0:18 offset1:21
    s_sub_u32 s41, s41, 1
    s_cbranch_scc1 L_pub_ffn
    s_waitcnt lgkmcnt(3)
    v_cmp_ne_u32 vcc, 7, v36
    s_cbranch_vccnz L_pc_ffn
    s_cmp_eq_u32 s45, 1
    s_waitcnt lgkmcnt(0)
    v_add_f32 v72, v76, v77
    v_add_f32 v73, v78, v79
    v_add_f32 v74, v80, v81
    v_add_f32_dpp v72, v72, v72 quad_perm:[1,0,3,2] row_mask:0xf bank_mask:0xf
    v_add_f32_dpp v73, v73, v73 quad_perm:[1,0,3,2] row_mask:0xf bank_mask:0xf
    v_add_f32_dpp v74, v74, v74 quad_perm:[1,0,3,2] row_mask:0xf bank_mask:0xf
    v_add_f32_dpp v72, v72, v72 quad_perm:[2,3,0,1] row_mask:0xf bank_mask:0xf
    v_add_f32_dpp v73, v73, v73 quad_perm:[2,3,0,1] row_mask:0xf bank_mask:0xf
    v_add_f32_dpp v74, v74, v74 quad_perm:[2,3,0,1] row_mask:0xf bank_mask:0xf
    s_mov_b32 exec_lo, 0x11111111
    s_mov_b32 exec_hi, 0x11111111
    s_cbranch_scc0 L_far_ffn
    global_store_dwordx4 v37, v[72:75], s[24:25]
L_pub_ffn:
    s_mov_b64 exec, -1
    s_cmp_lt_u32 s26, 4
    s_cbranch_scc0 L_helper_done
    s_sub_u32 s42, s2, 160
    s_sub_u32 s43, s30, 20
    s_mul_i32 s34, s29, 6
    s_add_u32 s43, s43, s34
    s_mul_i32 s34, s26, 491520
    s_lshl_b32 s35, s43, 6
    s_add_u32 s34, s34, s35
    s_add_u32 s16, s16, s34
    s_addc_u32 s17, s17, 0
    s_mul_i32 s34, s43, 40960
    s_lshl_b32 s35, s26, 7
    s_add_u32 s34, s34, s35
    s_add_u32 s34, s34, 2560
    s_add_u32 s18, s18, s34
    s_addc_u32 s19, s19, 0
    v_lshrrev_b32 v28, 4, v0
    v_and_b32 v29, 15, v0
    v_and_b32 v30, 3, v0
    v_and_b32 v31, 7, v0
    v_and_b32 v32, 12, v0
    v_lshl_add_u32 v32, v32, 2, v28
    v_mul_u32_u24 v32, 3072, v32
    v_lshl_add_u32 v32, v30, 4, v32
    v_and_b32 v33, 4, v0
    v_lshl_add_u32 v33, v33, 2, v28
    v_and_b32 v34, 8, v0
    v_add_u32 v33, v33, v34
    v_mul_u32_u24 v33, 3072, v33
    v_lshl_add_u32 v33, v30, 4, v33
    v_mul_u32_u24 v34, 5120, v2
    v_add_u32 v34, v34, v3
    s_mul_i32 s34, s26, 320
    v_lshl_add_u32 v35, v29, 2, v28
    v_lshl_add_u32 v35, v35, 1, s34
    v_lshl_add_u32 v14, v31, 2, v28
    v_lshl_add_u32 v36, v14, 1, s34
    global_load_ushort v8, v35, s[4:5]
    global_load_ushort v9, v35, s[4:5] offset:128
    global_load_ushort v10, v36, s[4:5] offset:256
    v_mov_b32 v27, 0
    v_min_u32 v1, 35, v0
    v_lshlrev_b32 v1, 5, v1
    v_add_u32 v1, 565248, v1
    global_load_dword v22, v1, s[24:25] sc1
    s_barrier
    ds_read_b32 v39, v27 offset:536
    s_bitcmp1_b32 s43, 0
    s_cbranch_scc1 L_wodd
    s_add_u32 s46, s16, 0
    s_addc_u32 s47, s17, 0
    global_load_dwordx4 v[80:83], v32, s[46:47]
    s_add_u32 s46, s16, 12288
    s_addc_u32 s47, s17, 0
    global_load_dwordx4 v[84:87], v32, s[46:47]
    s_add_u32 s46, s16, 24576
    s_addc_u32 s47, s17, 0
    global_load_dwordx4 v[88:91], v32, s[46:47]
    s_add_u32 s46, s16, 36864
    s_addc_u32 s47, s17, 0
    global_load_dwordx4 v[92:95], v32, s[46:47]
    s_add_u32 s46, s16, 196608
    s_addc_u32 s47, s17, 0
    global_load_dwordx4 v[96:99], v32, s[46:47]
    global_load_dwordx4 v[120:123], v34, s[18:19] offset:-2560 nt
    global_load_dwordx4 v[124:127], v34, s[18:19] offset:-1280 nt
    global_load_dwordx4 v[128:131], v34, s[18:19] offset:0 nt
    global_load_dwordx4 v[132:135], v34, s[18:19] offset:1280 nt
    global_load_dwordx4 v[136:139], v34, s[18:19] offset:-2048 nt
    global_load_dwordx4 v[140:143], v34, s[18:19] offset:-768 nt
    global_load_dwordx4 v[144:147], v34, s[18:19] offset:512 nt
    global_load_dwordx4 v[148:151], v34, s[18:19] offset:1792 nt
    s_cmp_lt_u32 s26, 2
    s_cbranch_scc0 L_w2_even
    global_load_dwordx4 v[152:155], v34, s[18:19] offset:-1536 nt
    global_load_dwordx4 v[156:159], v34, s[18:19] offset:-256 nt
    global_load_dwordx4 v[160:163], v34, s[18:19] offset:1024 nt
    global_load_dwordx4 v[164:167], v34, s[18:19] offset:2304 nt
L_w2_even:
    s_add_u32 s46, s16, 208896
    s_addc_u32 s47, s17, 0
    global_load_dwordx4 v[100:103], v32, s[46:47]
    s_add_u32 s46, s16, 221184
    s_addc_u32 s47, s17, 0
    global_load_dwordx4 v[104:107], v32, s[46:47]
    s_add_u32 s46, s16, 233472
    s_addc_u32 s47, s17, 0
    global_load_dwordx4 v[108:111], v32, s[46:47]
    s_add_u32 s46, s16, 393216
    s_addc_u32 s47, s17, 0
    global_load_dwordx4 v[112:115], v33, s[46:47]
    s_add_u32 s46, s16, 405504
    s_addc_u32 s47, s17, 0
    global_load_dwordx4 v[116:119], v33, s[46:47]
    s_branch L_wdone
L_wodd:
    s_add_u32 s46, s16, 208896
    s_addc_u32 s47, s17, 0
    global_load_dwordx4 v[100:103], v32, s[46:47]
    s_add_u32 s46, s16, 221184
    s_addc_u32 s47, s17, 0
    global_load_dwordx4 v[104:107], v32, s[46:47]
    s_add_u32 s46, s16, 233472
    s_addc_u32 s47, s17, 0
    global_load_dwordx4 v[108:111], v32, s[46:47]
    s_add_u32 s46, s16, 393216
    s_addc_u32 s47, s17, 0
    global_load_dwordx4 v[112:115], v33, s[46:47]
    s_add_u32 s46, s16, 405504
    s_addc_u32 s47, s17, 0
    global_load_dwordx4 v[116:119], v33, s[46:47]
    global_load_dwordx4 v[120:123], v34, s[18:19] offset:-2560 nt
    global_load_dwordx4 v[124:127], v34, s[18:19] offset:-1280 nt
    global_load_dwordx4 v[128:131], v34, s[18:19] offset:0 nt
    global_load_dwordx4 v[132:135], v34, s[18:19] offset:1280 nt
    global_load_dwordx4 v[136:139], v34, s[18:19] offset:-2048 nt
    global_load_dwordx4 v[140:143], v34, s[18:19] offset:-768 nt
    global_load_dwordx4 v[144:147], v34, s[18:19] offset:512 nt
    global_load_dwordx4 v[148:151], v34, s[18:19] offset:1792 nt
    s_cmp_lt_u32 s26, 2
    s_cbranch_scc0 L_w2_odd
    global_load_dwordx4 v[152:155], v34, s[18:19] offset:-1536 nt
    global_load_dwordx4 v[156:159], v34, s[18:19] offset:-256 nt
    global_load_dwordx4 v[160:163], v34, s[18:19] offset:1024 nt
    global_load_dwordx4 v[164:167], v34, s[18:19] offset:2304 nt
L_w2_odd:
    s_add_u32 s46, s16, 0
    s_addc_u32 s47, s17, 0
    global_load_dwordx4 v[80:83], v32, s[46:47]
    s_add_u32 s46, s16, 12288
    s_addc_u32 s47, s17, 0
    global_load_dwordx4 v[84:87], v32, s[46:47]
    s_add_u32 s46, s16, 24576
    s_addc_u32 s47, s17, 0
    global_load_dwordx4 v[88:91], v32, s[46:47]
    s_add_u32 s46, s16, 36864
    s_addc_u32 s47, s17, 0
    global_load_dwordx4 v[92:95], v32, s[46:47]
    s_add_u32 s46, s16, 196608
    s_addc_u32 s47, s17, 0
    global_load_dwordx4 v[96:99], v32, s[46:47]
L_wdone:
    s_lshl_b32 s35, s42, 6
    v_lshl_add_u32 v14, v14, 1, s35
    s_waitcnt lgkmcnt(0)
    v_readfirstlane_b32 s53, v39
    s_nop 0
    s_and_b32 s53, s53, 1
    s_lshl_b32 s53, s53, 13
    s_mul_i32 s34, s26, 640
    s_add_u32 s34, s34, s53
    s_add_u32 s35, s34, 573440
    v_lshlrev_b32 v15, 15, v28
    v_lshl_add_u32 v15, v29, 4, v15
    v_add_u32 v15, s35, v15
    v_add_u32 v20, 16384, v15
    s_add_u32 s35, s35, 512
    v_lshlrev_b32 v16, 14, v2
    v_add3_u32 v16, v16, v3, s35
    s_lshl_b32 s35, s26, 3
    v_mov_b32 v17, s35
    s_mul_i32 s35, s26, 768
    v_mul_u32_u24 v18, 192, v28
    v_lshl_add_u32 v18, v30, 5, v18
    v_add_u32 v18, s35, v18
    v_mul_u32_u24 v19, 12, v3
    v_lshl_add_u32 v19, v2, 4, v19
    s_lshl_b32 s35, s42, 14
    s_add_u32 s35, s35, s53
    s_add_u32 s35, s35, 707584
    v_lshl_add_u32 v21, v0, 4, s35
    v_or_b32 v12, v4, v6
    v_or_b32 v13, v5, v7
    v_bfe_u32 v11, v0, 3, 1
    v_add_u32 v11, -1, v11
    s_mul_i32 s43, s26, 5
    s_sub_u32 s43, s42, s43
    s_and_b32 s44, s43, 1
    s_lshl_b32 s44, s44, 3
    s_lshl_b32 s44, 0x00ff00ff, s44
    s_lshr_b32 s35, s43, 1
    s_cmp_eq_u32 s35, 1
    s_cselect_b64 s[50:51], -1, 0
    s_cmp_eq_u32 s35, 2
    s_cselect_b64 s[48:49], -1, 0
    s_waitcnt vmcnt(18)
    v_lshlrev_b32 v8, 16, v8
    v_lshlrev_b32 v9, 16, v9
    v_lshlrev_b32 v10, 16, v10
    s_and_b32 s36, s40, -2
    s_mov_b32 s41, 262144
L_f2:
    v_xor_b32 v22, s36, v22
    v_cmp_lt_u32 vcc, 1, v22
    s_cbranch_vccz L_f2_ok
    global_load_dword v22, v1, s[24:25] sc1
    s_waitcnt vmcnt(0)
    s_sub_u32 s41, s41, 1
    s_cbranch_scc0 L_f2
L_f2_ok:
    v_cmp_ne_u32 vcc, 0, v22
    s_nop 0
    s_mov_b32 s45, vcc_lo
    v_and_b32 v36, 1, v28
    v_lshlrev_b32 v36, 2, v36
    v_and_b32 v37, 2, v28
    v_add_u32 v36, v36, v37
    v_lshl_add_u32 v36, v30, 3, v36
    s_lshl_b32 s35, s42, 7
    s_add_u32 s35, s35, 704512
    v_lshl_add_u32 v36, v36, 2, s35
    s_lshl_b32 s34, s26, 1
    v_bfe_u32 v37, v0, 2, 1
    v_add_u32 v37, s34, v37
    v_lshrrev_b32 v38, v37, s45
    v_and_b32 v38, 1, v38
    v_lshl_add_u32 v38, v37, 1, v38
    v_lshl_add_u32 v32, v38, 13, v36
    v_add_u32 v37, 8, v37
    v_lshrrev_b32 v38, v37, s45
    v_and_b32 v38, 1, v38
    v_lshl_add_u32 v38, v37, 1, v38
    v_lshl_add_u32 v33, v38, 13, v36
    v_add_u32 v37, 8, v37
    v_lshrrev_b32 v38, v37, s45
    v_and_b32 v38, 1, v38
    v_lshl_add_u32 v38, v37, 1, v38
    v_lshl_add_u32 v34, v38, 13, v36
    global_load_dwordx4 v[40:43], v15, s[24:25] offset:0 sc1
    global_load_dwordx4 v[44:47], v15, s[24:25] offset:2560 sc1
    global_load_dwordx4 v[48:51], v20, s[24:25] offset:0 sc1
    global_load_dwordx4 v[52:55], v20, s[24:25] offset:2560 sc1
    global_load_dwordx4 v[56:59], v15, s[24:25] offset:256 sc1
    global_load_dwordx4 v[60:63], v15, s[24:25] offset:2816 sc1
    global_load_dwordx4 v[64:67], v20, s[24:25] offset:256 sc1
    global_load_dwordx4 v[68:71], v20, s[24:25] offset:2816 sc1
    global_load_dwordx4 v[72:75], v16, s[24:25] offset:0 sc1
    global_load_dwordx4 v[76:79], v16, s[24:25] offset:2560 sc1
    s_waitcnt vmcnt(10)
    v_swap_b32 v82, v84
    v_swap_b32 v83, v85
    v_swap_b32 v90, v92
    v_swap_b32 v91, v93
    v_swap_b32 v98, v100
    v_swap_b32 v99, v101
    v_swap_b32 v106, v108
    v_swap_b32 v107, v109
    v_swap_b32 v114, v116
    v_swap_b32 v115, v117
    s_mov_b32 s41, 262144
    s_branch L_py_in
L_py:
    s_sleep 1
    global_load_dwordx4 v[40:43], v15, s[24:25] offset:0 sc1
    global_load_dwordx4 v[44:47], v15, s[24:25] offset:2560 sc1
    global_load_dwordx4 v[48:51], v20, s[24:25] offset:0 sc1
    global_load_dwordx4 v[52:55], v20, s[24:25] offset:2560 sc1
    global_load_dwordx4 v[56:59], v15, s[24:25] offset:256 sc1
    global_load_dwordx4 v[60:63], v15, s[24:25] offset:2816 sc1
    global_load_dwordx4 v[64:67], v20, s[24:25] offset:256 sc1
    global_load_dwordx4 v[68:71], v20, s[24:25] offset:2816 sc1
    global_load_dwordx4 v[72:75], v16, s[24:25] offset:0 sc1
    global_load_dwordx4 v[76:79], v16, s[24:25] offset:2560 sc1
L_py_in:
    s_sub_u32 s41, s41, 1
    s_cbranch_scc1 L_py_giveup
    s_waitcnt vmcnt(6)
    v_pk_add_f32 v[40:41], v[40:41], v[44:45]
    v_pk_add_f32 v[42:43], v[42:43], v[46:47]
    v_pk_add_f32 v[48:49], v[48:49], v[52:53]
    v_pk_add_f32 v[50:51], v[50:51], v[54:55]
    v_pk_add_f32 v[40:41], v[40:41], v[48:49]
    v_pk_add_f32 v[42:43], v[42:43], v[50:51]
    s_waitcnt vmcnt(2)
    v_pk_add_f32 v[56:57], v[56:57], v[60:61]
    v_pk_add_f32 v[58:59], v[58:59], v[62:63]
    v_pk_add_f32 v[64:65], v[64:65], v[68:69]
    v_pk_add_f32 v[66:67], v[66:67], v[70:71]
    v_pk_add_f32 v[56:57], v[56:57], v[64:65]
    v_pk_add_f32 v[58:59], v[58:59], v[66:67]
    v_pk_add_f32 v[36:37], v[40:41], v[42:43]
    v_pk_add_f32 v[38:39], v[56:57], v[58:59]
    s_waitcnt vmcnt(0)
    v_pk_add_f32 v[72:73], v[72:73], v[76:77]
    v_pk_add_f32 v[74:75], v[74:75], v[78:79]
    v_pk_add_f32 v[36:37], v[36:37], v[72:73]
    v_pk_add_f32 v[38:39], v[38:39], v[74:75]
    v_pk_add_f32 v[36:37], v[36:37], v[38:39]
    v_cmp_u_f32 vcc, v36, v37
    s_nop 0
    s_and_b64 exec, exec, vcc
    s_cbranch_scc1 L_py
L_py_ok:
    s_mov_b64 exec, -1
    v_permlane32_swap_b32 v40, v42
    v_permlane32_swap_b32 v41, v43
    v_permlane32_swap_b32 v56, v58
    v_permlane32_swap_b32 v57, v59
    v_permlane32_swap_b32 v72, v74
    v_permlane32_swap_b32 v73, v75
    v_pk_add_f32 v[72:73], v[72:73], v[74:75]
    v_pk_add_f32 v[40:41], v[40:41], v[42:43]
    v_pk_add_f32 v[56:57], v[56:57], v[58:59]
    v_permlane16_swap_b32 v72, v73
    v_permlane16_swap_b32 v40, v41
    v_permlane16_swap_b32 v56, v57
    v_add_f32 v72, v72, v73
    v_add_f32 v40, v40, v41
    v_add_f32 v56, v56, v57
    v_add_f32_dpp v72, v72, v72 row_ror:8 row_mask:0xf bank_mask:0xf
    v_cvt_pk_bf16_f32 v40, 0, v40
    v_cvt_pk_bf16_f32 v56, 0, v56
    v_cvt_pk_bf16_f32 v72, 0, v72
    v_add_f32 v23, v8, v40
    v_add_f32 v24, v9, v56
    v_add_f32 v25, v10, v72
    v_cvt_pk_bf16_f32 v23, 0, v23
    v_cvt_pk_bf16_f32 v24, 0, v24
    v_cvt_pk_bf16_f32 v25, 0, v25
    v_add_f32 v40, v23, v24
    v_mul_f32 v41, v23, v23
    v_and_b32 v36, v11, v25
    v_fmac_f32 v41, v24, v24
    v_add_f32 v40, v40, v36
    v_fmac_f32 v41, v36, v36
    v_cndmask_b32 v26, v23, v24, s[50:51]
    v_add_f32_dpp v40, v40, v40 quad_perm:[1,0,3,2] row_mask:0xf bank_mask:0xf
    v_add_f32_dpp v41, v41, v41 quad_perm:[1,0,3,2] row_mask:0xf bank_mask:0xf
    v_cndmask_b32 v26, v26, v25, s[48:49]
    v_add_f32_dpp v40, v40, v40 quad_perm:[2,3,0,1] row_mask:0xf bank_mask:0xf
    v_add_f32_dpp v41, v41, v41 quad_perm:[2,3,0,1] row_mask:0xf bank_mask:0xf
    v_mov_b32_dpp v25, v25 quad_perm:[2,3,0,1] row_mask:0xf bank_mask:0xc
    v_add_f32_dpp v40, v40, v40 row_half_mirror row_mask:0xf bank_mask:0xf
    v_add_f32_dpp v41, v41, v41 row_half_mirror row_mask:0xf bank_mask:0xf
    s_nop 0
    v_add_f32_dpp v40, v40, v40 row_ror:8 row_mask:0xf bank_mask:0xf
    v_add_f32_dpp v41, v41, v41 row_ror:8 row_mask:0xf bank_mask:0xf
    s_nop 0
    v_add_f32_dpp v40, v40, v40 row_bcast:15 row_mask:0xa bank_mask:0xf
    v_add_f32_dpp v41, v41, v41 row_bcast:15 row_mask:0xa bank_mask:0xf
    s_nop 0
    v_add_f32_dpp v40, v40, v40 row_bcast:31 row_mask:0xc bank_mask:0xf
    v_add_f32_dpp v41, v41, v41 row_bcast:31 row_mask:0xc bank_mask:0xf
    s_lshl_b64 exec, 1, 63
    ds_write_b64 v17, v[40:41] offset:14336
    s_mov_b64 exec, -1
    s_waitcnt lgkmcnt(0)
    s_barrier
    ds_read_b128 v[40:43], v27 offset:14336
    ds_read_b128 v[44:47], v27 offset:14352
    s_waitcnt lgkmcnt(0)
    v_pk_add_f32 v[40:41], v[40:41], v[42:43]
    v_pk_add_f32 v[44:45], v[44:45], v[46:47]
    v_pk_add_f32 v[40:41], v[40:41], v[44:45]
    v_mul_f32 v42, 0x3acccccd, v40
    v_mul_f32 v43, 0x3acccccd, v41
    v_fma_f32 v43, -v42, v42, v43
    v_max_f32 v43, 0, v43
    v_cvt_pk_bf16_f32 v43, 0, v43
    v_add_f32 v43, 0x3727c5ac, v43
    v_cvt_pk_bf16_f32 v43, 0, v43
    v_sqrt_f32 v43, v43
    v_cvt_pk_bf16_f32 v42, 0, v42
    v_cvt_pk_bf16_f32 v43, 0, v43
    v_rcp_f32 v43, v43
    v_sub_f32 v44, v23, v42
    v_sub_f32 v45, v24, v42
    v_sub_f32 v46, v25, v42
    v_cvt_pk_bf16_f32 v44, 0, v44
    v_cvt_pk_bf16_f32 v45, 0, v45
    v_cvt_pk_bf16_f32 v46, 0, v46
    v_mul_f32 v44, v44, v43
    v_mul_f32 v45, v45, v43
    v_mul_f32 v46, v46, v43
    v_cvt_pk_bf16_f32 v44, v44, v44
    v_cvt_pk_bf16_f32 v45, v45, v45
    v_cvt_pk_bf16_f32 v46, v46, v46
    v_and_b32_dpp v48, v44, v12 quad_perm:[0,0,0,0] row_mask:0xf bank_mask:0xf
    v_and_b32_dpp v49, v44, v13 quad_perm:[0,0,0,0] row_mask:0xf bank_mask:0xf
    v_and_b32_dpp v50, v44, v12 quad_perm:[1,1,1,1] row_mask:0xf bank_mask:0xf
    v_and_b32_dpp v51, v44, v13 quad_perm:[1,1,1,1] row_mask:0xf bank_mask:0xf
    v_and_b32_dpp v52, v44, v12 quad_perm:[2,2,2,2] row_mask:0xf bank_mask:0xf
    v_and_b32_dpp v53, v44, v13 quad_perm:[2,2,2,2] row_mask:0xf bank_mask:0xf
    v_and_b32_dpp v54, v44, v12 quad_perm:[3,3,3,3] row_mask:0xf bank_mask:0xf
    v_and_b32_dpp v55, v44, v13 quad_perm:[3,3,3,3] row_mask:0xf bank_mask:0xf
    v_mfma_f32_16x16x32_bf16 v[68:71], v[48:51], v[80:83], 0
    v_mfma_f32_16x16x32_bf16 v[72:75], v[48:51], v[84:87], 0
    v_and_b32_dpp v56, v45, v12 quad_perm:[0,0,0,0] row_mask:0xf bank_mask:0xf
    v_and_b32_dpp v57, v45, v13 quad_perm:[0,0,0,0] row_mask:0xf bank_mask:0xf
    v_and_b32_dpp v58, v45, v12 quad_perm:[1,1,1,1] row_mask:0xf bank_mask:0xf
    v_and_b32_dpp v59, v45, v13 quad_perm:[1,1,1,1] row_mask:0xf bank_mask:0xf
    v_mfma_f32_16x16x32_bf16 v[68:71], v[52:55], v[88:91], v[68:71]
    v_mfma_f32_16x16x32_bf16 v[72:75], v[52:55], v[92:95], v[72:75]
    v_and_b32_dpp v60, v45, v12 quad_perm:[2,2,2,2] row_mask:0xf bank_mask:0xf
    v_and_b32_dpp v61, v45, v13 quad_perm:[2,2,2,2] row_mask:0xf bank_mask:0xf
    v_and_b32_dpp v62, v45, v12 quad_perm:[3,3,3,3] row_mask:0xf bank_mask:0xf
    v_and_b32_dpp v63, v45, v13 quad_perm:[3,3,3,3] row_mask:0xf bank_mask:0xf
    v_mfma_f32_16x16x32_bf16 v[68:71], v[56:59], v[96:99], v[68:71]
    v_mfma_f32_16x16x32_bf16 v[72:75], v[56:59], v[100:103], v[72:75]
    v_and_b32_dpp v64, v46, v12 quad_perm:[0,0,0,0] row_mask:0xf bank_mask:0xf
    v_and_b32_dpp v65, v46, v13 quad_perm:[0,0,0,0] row_mask:0xf bank_mask:0xf
    v_and_b32_dpp v66, v46, v12 quad_perm:[1,1,1,1] row_mask:0xf bank_mask:0xf
    v_and_b32_dpp v67, v46, v13 quad_perm:[1,1,1,1] row_mask:0xf bank_mask:0xf
    v_mfma_f32_16x16x32_bf16 v[68:71], v[60:63], v[104:107], v[68:71]
    v_mfma_f32_16x16x32_bf16 v[72:75], v[60:63], v[108:111], v[72:75]
    v_mfma_f32_16x16x32_bf16 v[68:71], v[64:67], v[112:115], v[68:71]
    v_mfma_f32_16x16x32_bf16 v[72:75], v[64:67], v[116:119], v[72:75]
    s_mov_b32 exec_lo, 0x00f0000f
    s_mov_b32 exec_hi, 0xf0000f00
    s_nop 4
    ds_write_b128 v18, v[68:71] offset:14592
    ds_write_b128 v18, v[72:75] offset:14608
    s_mov_b64 exec, -1
    s_waitcnt lgkmcnt(0)
    s_barrier
    ds_read_b128 v[40:43], v19 offset:14592
    ds_read_b128 v[44:47], v19 offset:16128
    s_waitcnt lgkmcnt(0)
    v_pk_add_f32 v[40:41], v[40:41], v[44:45]
    v_pk_add_f32 v[42:43], v[42:43], v[46:47]
    s_nop 0
    v_add_f32_dpp v40, v40, v40 quad_perm:[1,0,3,2] row_mask:0xf bank_mask:0xf
    v_add_f32_dpp v41, v41, v41 quad_perm:[1,0,3,2] row_mask:0xf bank_mask:0xf
    v_add_f32_dpp v42, v42, v42 quad_perm:[1,0,3,2] row_mask:0xf bank_mask:0xf
    v_add_f32_dpp v43, v43, v43 quad_perm:[1,0,3,2] row_mask:0xf bank_mask:0xf
    v_add_f32_dpp v40, v40, v40 quad_perm:[2,3,0,1] row_mask:0xf bank_mask:0xf
    v_add_f32_dpp v41, v41, v41 quad_perm:[2,3,0,1] row_mask:0xf bank_mask:0xf
    v_add_f32_dpp v42, v42, v42 quad_perm:[2,3,0,1] row_mask:0xf bank_mask:0xf
    v_add_f32_dpp v43, v43, v43 quad_perm:[2,3,0,1] row_mask:0xf bank_mask:0xf
    v_add_f32_dpp v40, v40, v40 row_half_mirror row_mask:0xf bank_mask:0xf
    v_add_f32_dpp v41, v41, v41 row_half_mirror row_mask:0xf bank_mask:0xf
    v_add_f32_dpp v42, v42, v42 row_half_mirror row_mask:0xf bank_mask:0xf
    v_add_f32_dpp v43, v43, v43 row_half_mirror row_mask:0xf bank_mask:0xf
    v_max_f32 v40, 0, v40
    v_max_f32 v41, 0, v41
    v_max_f32 v42, 0, v42
    v_max_f32 v43, 0, v43
    v_cvt_pk_bf16_f32 v40, v40, v40
    v_cvt_pk_bf16_f32 v41, v41, v41
    v_cvt_pk_bf16_f32 v42, v42, v42
    v_cvt_pk_bf16_f32 v43, v43, v43
    v_and_b32 v48, v4, v40
    v_and_b32 v49, v5, v40
    v_and_b32 v50, v6, v40
    v_and_b32 v51, v7, v40
    v_and_b32 v52, v4, v41
    v_and_b32 v53, v5, v41
    v_and_b32 v54, v6, v41
    v_and_b32 v55, v7, v41
    v_mfma_f32_16x16x32_bf16 v[68:71], v[48:51], v[120:123], 0
    v_and_b32 v56, v4, v42
    v_and_b32 v57, v5, v42
    v_and_b32 v58, v6, v42
    v_and_b32 v59, v7, v42
    v_mfma_f32_16x16x32_bf16 v[68:71], v[52:55], v[124:127], v[68:71]
    v_and_b32 v60, v4, v43
    v_and_b32 v61, v5, v43
    v_and_b32 v62, v6, v43
    v_and_b32 v63, v7, v43
    v_mfma_f32_16x16x32_bf16 v[68:71], v[56:59], v[128:131], v[68:71]
    s_nop 0
    v_mfma_f32_16x16x32_bf16 v[68:71], v[60:63], v[132:135], v[68:71]
    v_mfma_f32_16x16x32_bf16 v[72:75], v[48:51], v[136:139], 0
    v_mfma_f32_16x16x32_bf16 v[72:75], v[52:55], v[140:143], v[72:75]
    v_mfma_f32_16x16x32_bf16 v[72:75], v[56:59], v[144:147], v[72:75]
    v_mfma_f32_16x16x32_bf16 v[72:75], v[60:63], v[148:151], v[72:75]
    v_mfma_f32_16x16x32_bf16 v[76:79], v[48:51], v[152:155], 0
    v_mfma_f32_16x16x32_bf16 v[76:79], v[52:55], v[156:159], v[76:79]
    v_mfma_f32_16x16x32_bf16 v[76:79], v[56:59], v[160:163], v[76:79]
    v_mfma_f32_16x16x32_bf16 v[76:79], v[60:63], v[164:167], v[76:79]
    v_permlane32_swap_b32 v68, v70
    v_permlane32_swap_b32 v69, v71
    s_nop 0
    v_add_f32_dpp v68, v70, v68 row_ror:8 row_mask:0xf bank_mask:0xf
    v_add_f32_dpp v69, v71, v69 row_ror:8 row_mask:0xf bank_mask:0xf
    s_cmp_lt_u32 s26, 2
    v_permlane32_swap_b32 v72, v74
    v_permlane32_swap_b32 v73, v75
    s_nop 0
    v_add_f32_dpp v72, v74, v72 row_ror:8 row_mask:0xf bank_mask:0xf
    v_add_f32_dpp v73, v75, v73 row_ror:8 row_mask:0xf bank_mask:0xf
    v_permlane32_swap_b32 v76, v78
    v_permlane32_swap_b32 v77, v79
    s_nop 0
    v_add_f32_dpp v76, v78, v76 row_ror:8 row_mask:0xf bank_mask:0xf
    v_add_f32_dpp v77, v79, v77 row_ror:8 row_mask:0xf bank_mask:0xf
    s_mov_b32 exec_lo, 0x00ff00ff
    s_mov_b32 exec_hi, 0x00ff00ff
    global_store_dwordx2 v32, v[68:69], s[24:25] sc1
    global_store_dwordx2 v33, v[72:73], s[24:25] sc1
    s_cbranch_scc0 L_two
    global_store_dwordx2 v34, v[76:77], s[24:25] sc1
L_two:
    s_mov_b64 exec, -1
    s_cmp_lt_u32 s43, 5
    s_cbranch_scc0 L_notfinal
    s_mov_b32 s41, 262144
    s_waitcnt vmcnt(0)
L_pz:
    global_load_dwordx4 v[40:43], v21, s[24:25] offset:-3072 sc1
    global_load_dwordx4 v[44:47], v21, s[24:25] offset:-2048 sc1
    global_load_dwordx4 v[48:51], v21, s[24:25] offset:-1024 sc1
    global_load_dwordx4 v[52:55], v21, s[24:25] offset:0 sc1
    global_load_dwordx4 v[56:59], v21, s[24:25] offset:1024 sc1
    global_load_dwordx4 v[60:63], v21, s[24:25] offset:2048 sc1
    s_sub_u32 s41, s41, 1
    s_cbranch_scc1 L_pz_giveup
    s_waitcnt vmcnt(4)
    v_pk_add_f32 v[40:41], v[40:41], v[44:45]
    v_pk_add_f32 v[42:43], v[42:43], v[46:47]
    s_waitcnt vmcnt(3)
    v_pk_add_f32 v[40:41], v[40:41], v[48:49]
    v_pk_add_f32 v[42:43], v[42:43], v[50:51]
    s_waitcnt vmcnt(2)
    v_pk_add_f32 v[40:41], v[40:41], v[52:53]
    v_pk_add_f32 v[42:43], v[42:43], v[54:55]
    s_waitcnt vmcnt(1)
    v_pk_add_f32 v[40:41], v[40:41], v[56:57]
    v_pk_add_f32 v[42:43], v[42:43], v[58:59]
    s_waitcnt vmcnt(0)
    v_pk_add_f32 v[40:41], v[40:41], v[60:61]
    v_pk_add_f32 v[42:43], v[42:43], v[62:63]
    v_pk_add_f32 v[36:37], v[40:41], v[42:43]
    v_cmp_u_f32 vcc, v36, v37
    s_nop 0
    s_and_b64 exec, exec, vcc
    s_cbranch_scc1 L_pz
L_pz_ok:
    s_mov_b64 exec, -1
    v_permlane32_swap_b32 v40, v42
    v_permlane32_swap_b32 v41, v43
    v_pk_add_f32 v[40:41], v[40:41], v[42:43]
    s_nop 1
    v_permlane16_swap_b32 v40, v41
    v_add_f32 v40, v40, v41
    s_nop 1
    v_add_f32_dpp v40, v40, v40 row_ror:8 row_mask:0xf bank_mask:0xf
    v_cvt_pk_bf16_f32 v40, 0, v40
    v_add_f32 v40, v26, v40
    v_cvt_pk_bf16_f32 v40, v40, v40
    s_mov_b32 exec_lo, s44
    s_mov_b32 exec_hi, s44
    global_store_short v14, v40, s[20:21]
L_fin3:
    s_endpgm
L_py_giveup:
    s_waitcnt vmcnt(0)
    s_branch L_py_ok
L_pz_giveup:
    s_waitcnt vmcnt(0)
    s_branch L_pz_ok
L_notfinal:
    s_cmp_eq_u32 s43, 47
    s_cbranch_scc0 L_fin3
    v_mov_b32 v37, s40
    s_mov_b64 exec, 1
    global_store_dword v27, v37, s[24:25] offset:0 sc1
    s_endpgm
L_far_ffn:
    global_store_dwordx4 v37, v[72:75], s[24:25] sc1
    s_branch L_pub_ffn
L_end:
    s_endpgm
L_code_end:
.section .rodata,"a"
.p2align 6
.amdhsa_kernel sequential_preLN__sliding_block_cached__dense_activation_relu__decode_kernel
  .amdhsa_next_free_vgpr 168
  .amdhsa_next_free_sgpr 96
  .amdhsa_accum_offset 168
  .amdhsa_group_segment_fixed_size 0
  .amdhsa_kernarg_size 88
  .amdhsa_user_sgpr_count 2
  .amdhsa_user_sgpr_kernarg_segment_ptr 1
  .amdhsa_system_sgpr_workgroup_id_x 1
  .amdhsa_float_denorm_mode_32 3
.end_amdhsa_kernel
```
